```python
import torch

def _softmax(x, axis=-1):
    return torch.softmax(x, dim=axis)
def _gelu(x):
    return torch.nn.functional.gelu(x, approximate="tanh")
def _silu(x):
    return torch.nn.functional.silu(x)
def _sigmoid(x):
    return torch.sigmoid(x)
def _layernorm(x, axis=-1, eps=1e-5):
    m = x.mean(dim=axis, keepdim=True)
    v = x.var(dim=axis, keepdim=True, unbiased=False)
    return (x - m) / torch.sqrt(v + eps)
def _scatter_add(tgt, idx, src, axis=0):
    return tgt.clone().index_add_(axis, idx, src)
def _segment_sum(src, seg, n):
    out = torch.zeros((n,) + src.shape[1:], dtype=src.dtype)
    return out.index_add_(0, seg, src)
def _pad(x, pw):
    flat = tuple(v for pair in reversed(pw) for v in pair)
    return torch.nn.functional.pad(x, flat)

kernel_name = 'gather_scatter__edge_featured_mpnn_mpnn__graph'

def setup_inputs():

    _w = (lambda a: (lambda t: t.to(torch.bfloat16) if t.is_floating_point() else t)(torch.as_tensor(a)))
    N, deg, D, De = 10000, 16, 128, max(4, 1)
    E = N * deg
    H = 2 * D
    return {
        "x": _w((lambda *s: torch.randn(*s, dtype=torch.bfloat16) * 0.05)(N, D)),
        "e_attr": _w((lambda *s: torch.randn(*s, dtype=torch.bfloat16) * 1.6)(E, De)),
        "src": _w((lambda lo, hi, *s: torch.randint(lo, hi, s))(0, N, E).to(torch.int64)),
        "dst": _w((lambda lo, hi, *s: torch.randint(lo, hi, s))(0, N, E).to(torch.int64)),
        "w1": _w((lambda *s: torch.randn(*s, dtype=torch.bfloat16) * 1.6)(2 * D + De, H) * (1.0 / (2 * D + De) ** 0.5)),
        "b1": _w((lambda *s: torch.randn(*s, dtype=torch.bfloat16) * 3.2)(H) * 0.01),
        "w2": _w((lambda *s: torch.randn(*s, dtype=torch.bfloat16) * 0.05)(H, D) * (1.0 / H ** 0.5)),
        "b2": _w((lambda *s: torch.randn(*s, dtype=torch.bfloat16) * 0.1)(D) * 0.01),
    }

def reference(x, e_attr, src, dst, w1, b1, w2, b2):
    N, D = x.shape
    h_src = x[src]
    h_dst = x[dst]
    m_in = torch.concatenate([h_src, h_dst, e_attr], axis=-1)
    h = _silu(m_in @ w1 + b1)
    msg = h @ w2 + b2
    return _segment_sum(msg, dst, N)
```

```asm
; @launch grid=(256,1,1) block=(512,1,1) lds=148736
.amdgcn_target "amdgcn-amd-amdhsa--gfx950"
.text
.globl gather_scatter__edge_featured_mpnn_mpnn__graph_kernel
.p2align 8
.type gather_scatter__edge_featured_mpnn_mpnn__graph_kernel,@function
gather_scatter__edge_featured_mpnn_mpnn__graph_kernel:
    s_cmp_ge_u32 s2, 256
    s_cbranch_scc1 M_end
    s_load_dwordx16 s[4:19], s[0:1], 0
    s_load_dwordx4 s[20:23], s[0:1], 64
    s_load_dwordx2 s[24:25], s[0:1], 80
    v_lshrrev_b32 v2, 6, v0
    v_and_b32 v246, 63, v0
    v_readfirstlane_b32 s56, v2
    s_mul_i32 s57, s2, 160069
    s_add_u32 s58, s57, 164118
    s_add_u32 s57, s57, 4049
    s_lshr_b32 s57, s57, 12
    v_lshrrev_b32 v7, 4, v246
    v_and_b32 v8, 15, v246
    v_xor_b32 v8, v8, v7
    s_lshl_b32 s66, s56, 13
    s_and_b32 s3, s56, 1
    s_lshl_b32 s3, s3, 3
    v_xor_b32 v8, s3, v8
    v_lshlrev_b32 v8, 4, v8
    v_lshl_add_u32 v8, v7, 8, v8
    s_lshl_b32 s74, s56, 11
    v_add_u32 v145, s74, v8
    v_xor_b32 v146, 64, v145
    v_lshrrev_b32 v10, 2, v246
    v_and_b32 v11, 3, v246
    v_lshlrev_b32 v11, 4, v11
    v_lshl_add_u32 v10, v10, 9, v11
    s_lshl_b32 s3, s56, 6
    v_add_u32 v10, s3, v10
    v_lshlrev_b32 v2, 2, v0
    s_waitcnt lgkmcnt(0)
    s_cmp_ge_u32 s2, 64
    s_cbranch_scc1 M_pwg
    s_mov_b32 s44, s24
    s_mov_b32 s45, s25
    s_mov_b32 s46, 7294976
    s_mov_b32 s47, 0x00020000
    v_lshlrev_b32 v3, 7, v0
    s_cmp_eq_u32 s2, 0
    s_cselect_b32 s3, 48, 0
    v_cmp_gt_u32 vcc, s3, v0
    v_mov_b32 v4, 0x40000000
    v_mov_b32 v8, 0
    v_cndmask_b32 v3, v4, v3, vcc
    s_mul_i32 s3, s2, 10000
    buffer_store_dword v8, v3, s[44:47], 0 offen sc0 sc1
    s_add_u32 s36, s10, s3
    s_addc_u32 s37, s11, 0
    s_mov_b32 s38, 10000
    s_mov_b32 s39, 0x00020000
    s_add_u32 s40, s8, s3
    s_addc_u32 s41, s9, 0
    s_mov_b32 s42, 10000
    s_mov_b32 s43, 0x00020000
    s_mov_b32 s77, 4096
    s_mov_b32 s78, 8192
    buffer_load_dword v164, v2, s[36:39], 0 offen offset:0
    buffer_load_dword v165, v2, s[36:39], 0 offen offset:2048
    buffer_load_dword v166, v2, s[36:39], s77 offen offset:0
    buffer_load_dword v167, v2, s[36:39], s77 offen offset:2048
    buffer_load_dword v168, v2, s[36:39], s78 offen offset:0
    buffer_load_dword v169, v2, s[40:43], 0 offen offset:0
    buffer_load_dword v170, v2, s[40:43], 0 offen offset:2048
    buffer_load_dword v171, v2, s[40:43], s77 offen offset:0
    buffer_load_dword v172, v2, s[40:43], s77 offen offset:2048
    buffer_load_dword v173, v2, s[40:43], s78 offen offset:0
    s_mov_b32 s36, s16
    s_mov_b32 s37, s17
    s_mov_b32 s38, 65536
    s_mov_b32 s39, 0x00020000
    s_mov_b32 s32, s12
    s_mov_b32 s33, s13
    s_mov_b32 s34, 133120
    s_mov_b32 s35, 0x00020000
    v_lshlrev_b32 v3, 4, v0
    v_add_u32 v15, 65536, v3
    v_add_u32 v2, 98304, v2
    v_mov_b32 v4, -1
    v_mov_b32 v5, -1
    v_mov_b32 v6, -1
    v_mov_b32 v7, -1
    ds_write_b128 v15, v[4:7] offset:0
    ds_write_b128 v15, v[4:7] offset:8192
    ds_write_b128 v15, v[4:7] offset:16384
    ds_write_b128 v15, v[4:7] offset:24576
    ds_write_b32 v2, v8
    v_mov_b32 v9, 1
    s_mov_b32 s40, s4
    s_mov_b32 s41, s5
    s_mov_b32 s42, 2560000
    s_mov_b32 s43, 0x00020000
    s_mov_b32 s96, s22
    s_mov_b32 s97, s23
    s_mov_b32 s98, 256
    s_mov_b32 s99, 0x00020000
    s_waitcnt lgkmcnt(0)
    s_barrier
    s_waitcnt vmcnt(5)
    v_mul_u32_u24 v16, 1677, v164
    v_lshrrev_b32 v16, 16, v16
    v_lshlrev_b32 v21, 2, v16
    v_add_u32 v21, 98304, v21
    ds_add_rtn_u32 v26, v21, v9
    v_mul_u32_u24 v17, 1677, v165
    v_lshrrev_b32 v17, 16, v17
    v_lshlrev_b32 v22, 2, v17
    v_add_u32 v22, 98304, v22
    ds_add_rtn_u32 v27, v22, v9
    v_mul_u32_u24 v18, 1677, v166
    v_lshrrev_b32 v18, 16, v18
    v_lshlrev_b32 v23, 2, v18
    v_add_u32 v23, 98304, v23
    ds_add_rtn_u32 v28, v23, v9
    v_mul_u32_u24 v19, 1677, v167
    v_lshrrev_b32 v19, 16, v19
    v_lshlrev_b32 v24, 2, v19
    v_add_u32 v24, 98304, v24
    ds_add_rtn_u32 v29, v24, v9
    v_mul_u32_u24 v20, 1677, v168
    v_lshrrev_b32 v20, 16, v20
    v_lshlrev_b32 v25, 2, v20
    v_add_u32 v25, 98304, v25
    v_cmp_gt_u32 vcc, 452, v0
    s_and_saveexec_b64 s[78:79], vcc
    ds_add_rtn_u32 v30, v25, v9
    s_mov_b64 s[80:81], exec
    s_or_b32 s3, s2, s56
    s_cbranch_scc1 M_nf0
    s_mov_b64 exec, 1
    buffer_store_dword v9, off, s[96:99], 0 offset:128 sc0 sc1
M_nf0:
    s_mov_b64 exec, -1
    s_lshl_b32 s3, s2, 8
    v_add_u32 v3, s3, v0
    v_bfe_u32 v4, v3, 8, 3
    v_lshlrev_b32 v4, 5, v4
    v_bfe_u32 v5, v3, 6, 1
    v_lshl_add_u32 v4, v5, 4, v4
    v_bfe_u32 v5, v3, 1, 1
    v_lshl_add_u32 v4, v5, 3, v4
    v_bfe_u32 v5, v3, 7, 1
    v_lshl_add_u32 v4, v5, 2, v4
    v_and_b32 v5, 1, v3
    v_lshl_add_u32 v4, v5, 1, v4
    v_lshlrev_b32 v4, 8, v4
    v_lshrrev_b32 v5, 11, v3
    v_lshl_add_u32 v4, v5, 5, v4
    v_bfe_u32 v5, v3, 2, 4
    v_lshl_add_u32 v4, v5, 1, v4
    v_lshrrev_b32 v5, 8, v0
    v_lshl_or_b32 v4, v5, 30, v4
    v_lshlrev_b32 v3, 2, v3
    v_lshl_or_b32 v176, v5, 30, v3
    buffer_load_ushort v174, v4, s[36:39], 0 offen
    buffer_load_ushort v175, v4, s[36:39], 0 offen offset:256
    s_add_u32 m0, s74, 132352
    s_lshl_b32 s3, s57, 8
    buffer_load_dwordx4 v145, s[40:43], s3 offen lds
    buffer_load_dwordx4 v146, s[40:43], s3 offen offset:1024 lds
    s_mov_b32 s36, s14
    s_mov_b32 s37, s15
    s_mov_b32 s38, 512
    s_mov_b32 s39, 0x00020000
    v_lshrrev_b32 v3, 4, v246
    v_lshlrev_b32 v4, 4, v3
    s_lshl_b32 s3, s56, 6
    buffer_load_dwordx4 v[116:119], v4, s[36:39], s3 offen
    v_lshlrev_b32 v5, 2, v0
    s_mov_b32 s3, 131072
    buffer_load_dword v128, v5, s[32:35], s3 offen
    v_lshlrev_b32 v4, 3, v3
    s_mov_b32 s36, s18
    s_mov_b32 s37, s19
    s_mov_b32 s38, 256
    s_lshl_b32 s3, s56, 5
    buffer_load_dwordx2 v[230:231], v4, s[36:39], s3 offen
    s_waitcnt vmcnt(7)
    v_and_b32 v164, 63, v164
    v_lshl_or_b32 v169, v164, 14, v169
    v_add_u32 v164, 0, v0
    v_lshl_or_b32 v169, v164, 20, v169
    v_lshlrev_b32 v21, 7, v16
    v_add_u32 v21, 65536, v21
    v_and_b32 v165, 63, v165
    v_lshl_or_b32 v170, v165, 14, v170
    v_add_u32 v165, 512, v0
    v_lshl_or_b32 v170, v165, 20, v170
    v_lshlrev_b32 v22, 7, v17
    v_add_u32 v22, 65536, v22
    v_and_b32 v166, 63, v166
    v_lshl_or_b32 v171, v166, 14, v171
    v_add_u32 v166, 1024, v0
    v_lshl_or_b32 v171, v166, 20, v171
    v_lshlrev_b32 v23, 7, v18
    v_add_u32 v23, 65536, v23
    v_and_b32 v167, 63, v167
    v_lshl_or_b32 v172, v167, 14, v172
    v_add_u32 v167, 1536, v0
    v_lshl_or_b32 v172, v167, 20, v172
    v_lshlrev_b32 v24, 7, v19
    v_add_u32 v24, 65536, v24
    v_and_b32 v168, 63, v168
    v_lshl_or_b32 v173, v168, 14, v173
    v_add_u32 v168, 2048, v0
    v_lshl_or_b32 v173, v168, 20, v173
    v_lshlrev_b32 v25, 7, v20
    v_add_u32 v25, 65536, v25
    s_waitcnt lgkmcnt(4)
    v_add_u32 v4, v26, v16
    v_and_b32 v4, 7, v4
    v_lshrrev_b32 v5, 3, v26
    v_lshl_add_u32 v4, v4, 2, v5
    v_lshl_add_u32 v21, v4, 2, v21
    v_cmp_gt_u32 vcc, 32, v26
    s_and_saveexec_b64 s[82:83], vcc
    ds_write_b32 v21, v169
    s_mov_b64 exec, s[82:83]
    s_waitcnt lgkmcnt(3)
    v_add_u32 v4, v27, v17
    v_and_b32 v4, 7, v4
    v_lshrrev_b32 v5, 3, v27
    v_lshl_add_u32 v4, v4, 2, v5
    v_lshl_add_u32 v22, v4, 2, v22
    v_cmp_gt_u32 vcc, 32, v27
    s_and_saveexec_b64 s[82:83], vcc
    ds_write_b32 v22, v170
    s_mov_b64 exec, s[82:83]
    s_waitcnt lgkmcnt(2)
    v_add_u32 v4, v28, v18
    v_and_b32 v4, 7, v4
    v_lshrrev_b32 v5, 3, v28
    v_lshl_add_u32 v4, v4, 2, v5
    v_lshl_add_u32 v23, v4, 2, v23
    v_cmp_gt_u32 vcc, 32, v28
    s_and_saveexec_b64 s[82:83], vcc
    ds_write_b32 v23, v171
    s_mov_b64 exec, s[82:83]
    s_waitcnt lgkmcnt(1)
    v_add_u32 v4, v29, v19
    v_and_b32 v4, 7, v4
    v_lshrrev_b32 v5, 3, v29
    v_lshl_add_u32 v4, v4, 2, v5
    v_lshl_add_u32 v24, v4, 2, v24
    v_cmp_gt_u32 vcc, 32, v29
    s_and_saveexec_b64 s[82:83], vcc
    ds_write_b32 v24, v172
    s_mov_b64 exec, s[82:83]
    s_mov_b64 exec, s[80:81]
    s_waitcnt lgkmcnt(0)
    v_add_u32 v4, v30, v20
    v_and_b32 v4, 7, v4
    v_lshrrev_b32 v5, 3, v30
    v_lshl_add_u32 v4, v4, 2, v5
    v_lshl_add_u32 v25, v4, 2, v25
    v_cmp_gt_u32 vcc, 32, v30
    s_and_saveexec_b64 s[82:83], vcc
    ds_write_b32 v25, v173
    s_mov_b64 exec, s[82:83]
    s_mov_b64 exec, -1
    v_lshrrev_b32 v4, 3, v0
    v_lshlrev_b32 v5, 2, v4
    v_add_u32 v5, 98304, v5
    v_and_b32 v6, 7, v0
    v_lshlrev_b32 v7, 13, v4
    v_lshl_add_u32 v7, v6, 4, v7
    s_lshl_b32 s3, s2, 7
    s_add_u32 s3, s3, 73728
    v_add_u32 v7, s3, v7
    v_cmp_eq_u32 s[78:79], 7, v6
    v_mov_b32 v8, -2
    s_mov_b32 s80, 0
    s_mov_b32 s81, 524288
    s_mov_b32 s82, 1048576
    s_mov_b32 s83, 1572864
    s_waitcnt lgkmcnt(0)
    s_barrier
    ds_read_b128 v[16:19], v15 offset:0
    ds_read_b32 v32, v5 offset:0
    ds_read_b128 v[20:23], v15 offset:8192
    ds_read_b32 v33, v5 offset:256
    ds_read_b128 v[24:27], v15 offset:16384
    ds_read_b32 v34, v5 offset:512
    ds_read_b128 v[28:31], v15 offset:24576
    ds_read_b32 v35, v5 offset:768
    s_mov_b32 s3, 8192
    s_waitcnt lgkmcnt(6)
    v_cmp_lt_u32 vcc, 32, v32
    s_and_b64 vcc, vcc, s[78:79]
    s_nop 1
    v_cndmask_b32 v19, v19, v8, vcc
    buffer_store_dwordx4 v[16:19], v7, s[44:47], s80 offen sc0 sc1
    s_waitcnt lgkmcnt(4)
    v_cmp_lt_u32 vcc, 32, v33
    s_and_b64 vcc, vcc, s[78:79]
    s_nop 1
    v_cndmask_b32 v23, v23, v8, vcc
    buffer_store_dwordx4 v[20:23], v7, s[44:47], s81 offen sc0 sc1
    s_waitcnt lgkmcnt(2)
    v_cmp_lt_u32 vcc, 32, v34
    s_and_b64 vcc, vcc, s[78:79]
    s_nop 1
    v_cndmask_b32 v27, v27, v8, vcc
    buffer_store_dwordx4 v[24:27], v7, s[44:47], s82 offen sc0 sc1
    s_waitcnt lgkmcnt(0)
    v_cmp_lt_u32 vcc, 32, v35
    s_and_b64 vcc, vcc, s[78:79]
    s_nop 1
    v_cndmask_b32 v31, v31, v8, vcc
    buffer_store_dwordx4 v[28:31], v7, s[44:47], s83 offen sc0 sc1
    s_waitcnt vmcnt(9)
    v_lshl_or_b32 v174, v175, 16, v174
    buffer_store_dword v174, v176, s[44:47], s3 offen sc0 sc1
    buffer_load_dword v129, off, s[96:99], 0 offset:128 sc1
    v_lshrrev_b32 v3, 4, v246
    v_and_b32 v4, 15, v246
    v_xor_b32 v5, v3, v4
    v_lshlrev_b32 v5, 4, v5
    v_lshl_add_u32 v147, v4, 8, v5
    v_bfe_u32 v5, v246, 2, 2
    v_lshl_add_u32 v6, v3, 3, v5
    v_lshlrev_b32 v6, 6, v6
    v_and_b32 v7, 3, v246
    v_lshl_add_u32 v6, v7, 4, v6
    v_add_u32 v14, s66, v6
    v_mov_b32 v12, 0xbfb8aa3b
    v_mov_b32 v13, v12
    s_add_u32 s48, s24, 2170880
    s_addc_u32 s49, s25, 0
    s_mov_b32 s50, 5124096
    s_mov_b32 s51, 0x00020000
    s_mov_b32 s52, s6
    s_mov_b32 s53, s7
    s_mov_b32 s54, 1280000
    s_mov_b32 s55, 0x00020000
    s_lshr_b32 s58, s58, 12
    s_min_u32 s58, s58, 10000
    s_sub_u32 s59, s58, s57
    s_lshl_b32 s69, s57, 2
    s_add_u32 s70, s66, 4096
    s_mov_b32 s64, 0
    s_mov_b32 s83, 0
    s_lshl_b32 s26, s56, 13
    s_add_u32 s26, s26, 8192
    s_add_u32 s27, s26, 4096
    v_lshrrev_b32 v3, 4, v246
    v_bfe_u32 v5, v246, 2, 2
    v_and_b32 v7, 3, v246
    v_xor_b32 v9, v7, v3
    v_lshlrev_b32 v9, 4, v9
    s_lshl_b32 s3, s56, 6
    s_add_u32 s76, s3, 1024
    v_add_u32 v235, s76, v9
    v_add_u32 v234, 1024, v235
    v_add_u32 v233, 2048, v235
    v_add_u32 v232, 3072, v235
    v_lshrrev_b32 v1, 5, v246
    v_mul_u32_u24 v5, 592, v5
    v_and_b32 v3, 1, v3
    v_lshl_add_u32 v5, v3, 5, v5
    v_lshl_add_u32 v5, v7, 3, v5
    s_add_u32 s3, s3, 111104
    v_add_u32 v5, s3, v5
    v_mul_u32_u24 v6, 4736, v1
    v_add_u32 v241, v5, v6
    v_mul_u32_u24 v242, 148, v1
    v_and_b32 v3, 31, v246
    v_lshrrev_b32 v9, 3, v3
    v_and_b32 v8, 3, v3
    v_lshl_add_u32 v9, v8, 2, v9
    v_and_b32 v8, 4, v3
    v_lshl_add_u32 v9, v8, 2, v9
    v_lshlrev_b32 v9, 4, v9
    v_mul_u32_u24 v8, 13312, v1
    v_add_u32 v9, v9, v8
    v_add_u32 v236, 65536, v9
    v_lshrrev_b32 v9, 2, v246
    v_and_b32 v8, 3, v9
    v_lshlrev_b32 v8, 2, v8
    v_lshrrev_b32 v11, 3, v9
    v_lshl_add_u32 v8, v11, 1, v8
    v_and_b32 v11, 4, v9
    v_lshl_add_u32 v8, v11, 2, v8
    v_lshlrev_b32 v8, 2, v8
    v_add_u32 v238, 106496, v8
    v_and_b32 v8, 7, v3
    v_and_b32 v9, 8, v3
    v_lshl_add_u32 v8, v9, 1, v8
    v_lshrrev_b32 v9, 4, v3
    v_lshl_add_u32 v8, v9, 3, v8
    v_bfe_u32 v9, v8, 2, 2
    v_xor_b32 v9, v9, v1
    v_lshlrev_b32 v9, 4, v9
    v_lshl_add_u32 v9, v8, 6, v9
    v_add_u32 v239, s66, v9
    v_xor_b32 v240, 32, v239
    v_and_b32 v9, 1, v3
    v_lshlrev_b32 v9, 4, v9
    v_mov_b32 v8, 0x3f80
    v_lshlrev_b32 v9, v9, v8
    v_lshrrev_b32 v8, 1, v3
    v_lshlrev_b32 v11, 2, v1
    v_sub_u32 v8, v8, v11
    v_cmp_eq_u32 s[76:77], 0, v8
    v_cmp_eq_u32 vcc, 8, v8
    s_nop 0
    v_cndmask_b32 v136, 0, v9, s[76:77]
    v_cndmask_b32 v140, 0, v9, vcc
    v_cmp_eq_u32 s[76:77], 1, v8
    v_cmp_eq_u32 vcc, 9, v8
    s_nop 0
    v_cndmask_b32 v137, 0, v9, s[76:77]
    v_cndmask_b32 v141, 0, v9, vcc
    v_cmp_eq_u32 s[76:77], 2, v8
    v_cmp_eq_u32 vcc, 10, v8
    s_nop 0
    v_cndmask_b32 v138, 0, v9, s[76:77]
    v_cndmask_b32 v142, 0, v9, vcc
    v_cmp_eq_u32 s[76:77], 3, v8
    v_cmp_eq_u32 vcc, 11, v8
    s_nop 0
    v_cndmask_b32 v139, 0, v9, s[76:77]
    v_cndmask_b32 v143, 0, v9, vcc
    v_mov_b32 v228, 0x27800000
    v_mov_b32 v229, 0x27800000
    v_mov_b32 v244, 0
    v_mov_b32 v247, 0x80000000
    v_lshrrev_b32 v9, 3, v0
    v_mul_u32_u24 v245, 20000, v9
    v_lshlrev_b32 v249, 4, v246
    v_lshlrev_b32 v9, 2, v246
    v_add_u32 v250, 110592, v9
    v_mov_b32 v84, 0
    v_mov_b32 v100, 0
    v_mov_b32 v85, 0
    v_mov_b32 v101, 0
    v_mov_b32 v86, 0
    v_mov_b32 v102, 0
    v_mov_b32 v87, 0
    v_mov_b32 v103, 0
    v_mov_b32 v88, 0
    v_mov_b32 v104, 0
    v_mov_b32 v89, 0
    v_mov_b32 v105, 0
    v_mov_b32 v90, 0
    v_mov_b32 v106, 0
    v_mov_b32 v91, 0
    v_mov_b32 v107, 0
    v_mov_b32 v92, 0
    v_mov_b32 v108, 0
    v_mov_b32 v93, 0
    v_mov_b32 v109, 0
    v_mov_b32 v94, 0
    v_mov_b32 v110, 0
    v_mov_b32 v95, 0
    v_mov_b32 v111, 0
    v_mov_b32 v96, 0
    v_mov_b32 v112, 0
    v_mov_b32 v97, 0
    v_mov_b32 v113, 0
    v_mov_b32 v98, 0
    v_mov_b32 v114, 0
    v_mov_b32 v99, 0
    v_mov_b32 v115, 0
    s_waitcnt vmcnt(0)
    s_barrier
    s_cmp_lg_u32 s56, 0
    s_cbranch_scc1 M_nlast2
    s_and_b32 s3, s2, 1
    s_lshl_b32 s3, s3, 6
    s_mov_b32 s76, 1
    s_atomic_add s76, s[22:23], s3 glc
    v_readfirstlane_b32 s3, v129
    s_cmp_lg_u32 s3, 0
    s_cbranch_scc1 M_pfdb
    s_mov_b32 s71, 0x40000
M_spfb:
    s_mov_b32 s77, 0
    s_atomic_add s77, s[22:23], 128 glc
    s_sub_u32 s71, s71, 1
    s_cbranch_scc1 M_spdfb
    s_waitcnt lgkmcnt(0)
    s_cmp_lg_u32 s77, 1
    s_cbranch_scc1 M_spfb
M_spdfb:
    s_waitcnt lgkmcnt(0)
M_pfdb:
    s_waitcnt lgkmcnt(0)
    s_and_b32 s3, s76, 31
    s_cmp_lg_u32 s3, 31
    s_cbranch_scc1 M_nlast
    s_mov_b32 s84, 1
    s_atomic_add s84, s[24:25], 2048
    s_atomic_add s84, s[24:25], 2176
    s_atomic_add s84, s[24:25], 2304
    s_atomic_add s84, s[24:25], 2432
    s_atomic_add s84, s[24:25], 2560
    s_atomic_add s84, s[24:25], 2688
    s_atomic_add s84, s[24:25], 2816
    s_atomic_add s84, s[24:25], 2944
    s_atomic_add s84, s[24:25], 3072
    s_atomic_add s84, s[24:25], 3200
    s_atomic_add s84, s[24:25], 3328
    s_atomic_add s84, s[24:25], 3456
    s_atomic_add s84, s[24:25], 3584
    s_atomic_add s84, s[24:25], 3712
    s_atomic_add s84, s[24:25], 3840
    s_atomic_add s84, s[24:25], 3968
M_nlast:
M_nlast2:
    s_mov_b32 s28, s24
    s_mov_b32 s29, s25
    s_mov_b32 s30, 0
    s_mov_b32 s31, 0x00020000
    v_mov_b32 v144, 0
    s_add_u32 m0, s66, 0
    s_mov_b32 s77, 65536
    buffer_load_dwordx4 v10, s[32:35], s77 offen lds
    s_add_u32 m0, s66, 1024
    s_mov_b32 s77, 73728
    buffer_load_dwordx4 v10, s[32:35], s77 offen lds
    s_add_u32 m0, s66, 2048
    s_mov_b32 s77, 81920
    buffer_load_dwordx4 v10, s[32:35], s77 offen lds
    s_add_u32 m0, s66, 3072
    s_mov_b32 s77, 90112
    buffer_load_dwordx4 v10, s[32:35], s77 offen lds
    s_add_u32 m0, s66, 4096
    s_mov_b32 s77, 98304
    buffer_load_dwordx4 v10, s[32:35], s77 offen lds
    s_add_u32 m0, s66, 5120
    s_mov_b32 s77, 106496
    buffer_load_dwordx4 v10, s[32:35], s77 offen lds
    s_add_u32 m0, s66, 6144
    s_mov_b32 s77, 114688
    buffer_load_dwordx4 v10, s[32:35], s77 offen lds
    s_add_u32 m0, s66, 7168
    s_mov_b32 s77, 122880
    buffer_load_dwordx4 v10, s[32:35], s77 offen lds
    v_mov_b32 v40, 0
    v_mov_b32 v41, 0
    v_mov_b32 v42, 0
    v_mov_b32 v43, 0
    v_mov_b32 v44, 4194304
    v_mov_b32 v45, 4194304
    v_lshlrev_b32 v1, 3, v0
    v_add_u32 v1, 106496, v1
    ds_write_b64 v1, v[44:45]
    ds_write_b32 v250, v40
    ds_write_b32 v250, v40 offset:256
    v_lshlrev_b32 v1, 4, v0
    v_add_u32 v1, 65536, v1
    ds_write_b128 v1, v[40:43] offset:0
    ds_write_b128 v1, v[40:43] offset:8192
    ds_write_b128 v1, v[40:43] offset:16384
    ds_write_b128 v1, v[40:43] offset:24576
    ds_write_b128 v1, v[40:43] offset:32768
    s_branch M_join
M_pwg:
    s_mov_b32 s40, s4
    s_mov_b32 s41, s5
    s_mov_b32 s42, 2560000
    s_mov_b32 s43, 0x00020000
    s_mov_b32 s32, s12
    s_mov_b32 s33, s13
    s_mov_b32 s34, 133120
    s_mov_b32 s35, 0x00020000
    s_sub_u32 s62, s2, 64
    s_mul_i32 s62, s62, 53
    s_add_u32 m0, s74, 115968
    s_lshl_b32 s3, s62, 8
    buffer_load_dwordx4 v145, s[40:43], s3 offen lds
    buffer_load_dwordx4 v146, s[40:43], s3 offen offset:1024 lds
    s_and_b32 s3, s2, -8
    s_add_u32 s3, s3, s56
    s_and_b32 s3, s3, 127
    s_lshl_b32 s3, s3, 10
    v_lshlrev_b32 v3, 4, v246
    buffer_load_dwordx4 v[16:19], v3, s[32:35], s3 offen
    s_mov_b32 s44, s24
    s_mov_b32 s45, s25
    s_mov_b32 s46, 7294976
    s_mov_b32 s47, 0x00020000
    s_mov_b32 s96, s22
    s_mov_b32 s97, s23
    s_mov_b32 s98, 256
    s_mov_b32 s99, 0x00020000
    s_add_u32 s48, s24, 2170880
    s_addc_u32 s49, s25, 0
    s_mov_b32 s50, 5124096
    s_mov_b32 s51, 0x00020000
    s_mov_b32 s52, s6
    s_mov_b32 s53, s7
    s_mov_b32 s54, 1280000
    s_mov_b32 s55, 0x00020000
    s_lshr_b32 s58, s58, 12
    s_min_u32 s58, s58, 10000
    s_sub_u32 s59, s58, s57
    s_lshl_b32 s69, s57, 2
    s_add_u32 s70, s66, 4096
    s_mov_b32 s64, 0
    s_mov_b32 s83, 0
    s_lshl_b32 s26, s56, 13
    s_add_u32 s26, s26, 8192
    s_add_u32 s27, s26, 4096
    v_lshrrev_b32 v3, 4, v246
    v_bfe_u32 v5, v246, 2, 2
    v_and_b32 v7, 3, v246
    v_xor_b32 v9, v7, v3
    v_lshlrev_b32 v9, 4, v9
    s_lshl_b32 s3, s56, 6
    s_add_u32 s76, s3, 1024
    v_add_u32 v235, s76, v9
    v_add_u32 v234, 1024, v235
    v_add_u32 v233, 2048, v235
    v_add_u32 v232, 3072, v235
    v_lshrrev_b32 v1, 5, v246
    v_mul_u32_u24 v5, 592, v5
    v_and_b32 v3, 1, v3
    v_lshl_add_u32 v5, v3, 5, v5
    v_lshl_add_u32 v5, v7, 3, v5
    s_add_u32 s3, s3, 111104
    v_add_u32 v5, s3, v5
    v_mul_u32_u24 v6, 4736, v1
    v_add_u32 v241, v5, v6
    v_mul_u32_u24 v242, 148, v1
    v_and_b32 v3, 31, v246
    v_lshrrev_b32 v9, 3, v3
    v_and_b32 v8, 3, v3
    v_lshl_add_u32 v9, v8, 2, v9
    v_and_b32 v8, 4, v3
    v_lshl_add_u32 v9, v8, 2, v9
    v_lshlrev_b32 v9, 4, v9
    v_mul_u32_u24 v8, 13312, v1
    v_add_u32 v9, v9, v8
    v_add_u32 v236, 65536, v9
    v_lshrrev_b32 v9, 2, v246
    v_and_b32 v8, 3, v9
    v_lshlrev_b32 v8, 2, v8
    v_lshrrev_b32 v11, 3, v9
    v_lshl_add_u32 v8, v11, 1, v8
    v_and_b32 v11, 4, v9
    v_lshl_add_u32 v8, v11, 2, v8
    v_lshlrev_b32 v8, 2, v8
    v_add_u32 v238, 106496, v8
    v_and_b32 v8, 7, v3
    v_and_b32 v9, 8, v3
    v_lshl_add_u32 v8, v9, 1, v8
    v_lshrrev_b32 v9, 4, v3
    v_lshl_add_u32 v8, v9, 3, v8
    v_bfe_u32 v9, v8, 2, 2
    v_xor_b32 v9, v9, v1
    v_lshlrev_b32 v9, 4, v9
    v_lshl_add_u32 v9, v8, 6, v9
    v_add_u32 v239, s66, v9
    v_xor_b32 v240, 32, v239
    v_and_b32 v9, 1, v3
    v_lshlrev_b32 v9, 4, v9
    v_mov_b32 v8, 0x3f80
    v_lshlrev_b32 v9, v9, v8
    v_lshrrev_b32 v8, 1, v3
    v_lshlrev_b32 v11, 2, v1
    v_sub_u32 v8, v8, v11
    v_cmp_eq_u32 s[76:77], 0, v8
    v_cmp_eq_u32 vcc, 8, v8
    s_nop 0
    v_cndmask_b32 v136, 0, v9, s[76:77]
    v_cndmask_b32 v140, 0, v9, vcc
    v_cmp_eq_u32 s[76:77], 1, v8
    v_cmp_eq_u32 vcc, 9, v8
    s_nop 0
    v_cndmask_b32 v137, 0, v9, s[76:77]
    v_cndmask_b32 v141, 0, v9, vcc
    v_cmp_eq_u32 s[76:77], 2, v8
    v_cmp_eq_u32 vcc, 10, v8
    s_nop 0
    v_cndmask_b32 v138, 0, v9, s[76:77]
    v_cndmask_b32 v142, 0, v9, vcc
    v_cmp_eq_u32 s[76:77], 3, v8
    v_cmp_eq_u32 vcc, 11, v8
    s_nop 0
    v_cndmask_b32 v139, 0, v9, s[76:77]
    v_cndmask_b32 v143, 0, v9, vcc
    v_mov_b32 v228, 0x27800000
    v_mov_b32 v229, 0x27800000
    v_mov_b32 v244, 0
    v_mov_b32 v247, 0x80000000
    v_lshrrev_b32 v9, 3, v0
    v_mul_u32_u24 v245, 20000, v9
    v_lshlrev_b32 v249, 4, v246
    v_lshlrev_b32 v9, 2, v246
    v_add_u32 v250, 110592, v9
    v_mov_b32 v84, 0
    v_mov_b32 v100, 0
    v_mov_b32 v85, 0
    v_mov_b32 v101, 0
    v_mov_b32 v86, 0
    v_mov_b32 v102, 0
    v_mov_b32 v87, 0
    v_mov_b32 v103, 0
    v_mov_b32 v88, 0
    v_mov_b32 v104, 0
    v_mov_b32 v89, 0
    v_mov_b32 v105, 0
    v_mov_b32 v90, 0
    v_mov_b32 v106, 0
    v_mov_b32 v91, 0
    v_mov_b32 v107, 0
    v_mov_b32 v92, 0
    v_mov_b32 v108, 0
    v_mov_b32 v93, 0
    v_mov_b32 v109, 0
    v_mov_b32 v94, 0
    v_mov_b32 v110, 0
    v_mov_b32 v95, 0
    v_mov_b32 v111, 0
    v_mov_b32 v96, 0
    v_mov_b32 v112, 0
    v_mov_b32 v97, 0
    v_mov_b32 v113, 0
    v_mov_b32 v98, 0
    v_mov_b32 v114, 0
    v_mov_b32 v99, 0
    v_mov_b32 v115, 0
    v_mov_b32 v40, 0
    v_mov_b32 v41, 0
    v_mov_b32 v42, 0
    v_mov_b32 v43, 0
    v_mov_b32 v44, 4194304
    v_mov_b32 v45, 4194304
    v_lshlrev_b32 v1, 3, v0
    v_add_u32 v1, 106496, v1
    ds_write_b64 v1, v[44:45]
    ds_write_b32 v250, v40
    ds_write_b32 v250, v40 offset:256
    v_lshlrev_b32 v1, 4, v0
    v_add_u32 v1, 65536, v1
    ds_write_b128 v1, v[40:43] offset:0
    ds_write_b128 v1, v[40:43] offset:8192
    ds_write_b128 v1, v[40:43] offset:16384
    ds_write_b128 v1, v[40:43] offset:24576
    ds_write_b128 v1, v[40:43] offset:32768
    s_add_u32 m0, s66, 0
    s_mov_b32 s77, 0
    buffer_load_dwordx4 v10, s[32:35], s77 offen lds
    s_add_u32 m0, s66, 1024
    s_mov_b32 s77, 8192
    buffer_load_dwordx4 v10, s[32:35], s77 offen lds
    s_add_u32 m0, s66, 2048
    s_mov_b32 s77, 16384
    buffer_load_dwordx4 v10, s[32:35], s77 offen lds
    s_add_u32 m0, s66, 3072
    s_mov_b32 s77, 24576
    buffer_load_dwordx4 v10, s[32:35], s77 offen lds
    s_add_u32 m0, s66, 4096
    s_mov_b32 s77, 32768
    buffer_load_dwordx4 v10, s[32:35], s77 offen lds
    s_add_u32 m0, s66, 5120
    s_mov_b32 s77, 40960
    buffer_load_dwordx4 v10, s[32:35], s77 offen lds
    s_add_u32 m0, s66, 6144
    s_mov_b32 s77, 49152
    buffer_load_dwordx4 v10, s[32:35], s77 offen lds
    s_add_u32 m0, s66, 7168
    s_mov_b32 s77, 57344
    buffer_load_dwordx4 v10, s[32:35], s77 offen lds
    v_lshrrev_b32 v3, 4, v246
    v_and_b32 v4, 15, v246
    v_xor_b32 v5, v3, v4
    v_lshlrev_b32 v5, 4, v5
    v_lshl_add_u32 v147, v4, 8, v5
    v_bfe_u32 v5, v246, 2, 2
    v_lshl_add_u32 v6, v3, 3, v5
    v_lshlrev_b32 v6, 6, v6
    v_and_b32 v7, 3, v246
    v_lshl_add_u32 v6, v7, 4, v6
    v_add_u32 v14, s66, v6
    v_mov_b32 v12, 0xbfb8aa3b
    v_mov_b32 v13, v12
    v_add_u32 v15, 115968, v147
    v_add_u32 v11, s62, v4
    v_lshlrev_b32 v11, 9, v11
    v_lshl_add_u32 v11, v3, 4, v11
    s_lshl_b32 s3, s56, 6
    v_add_u32 v144, s3, v11
    s_add_u32 s3, s62, 53
    s_min_u32 s3, s3, 10000
    s_lshl_b32 s3, s3, 9
    s_add_u32 s28, s24, 2174976
    s_addc_u32 s29, s25, 0
    s_mov_b32 s30, s3
    s_mov_b32 s31, 0x00020000
    s_waitcnt vmcnt(8)
    s_barrier
    ds_read_b128 v[160:163], v15 offset:0
    ds_read_b128 v[176:179], v15 offset:4096
    ds_read_b128 v[192:195], v15 offset:8192
    ds_read_b128 v[208:211], v15 offset:12288
    s_waitcnt vmcnt(6)
    ds_read_b64_tr_b16 v[16:17], v14 offset:0
    ds_read_b64_tr_b16 v[18:19], v14 offset:256
    ds_read_b64_tr_b16 v[20:21], v14 offset:8
    ds_read_b64_tr_b16 v[22:23], v14 offset:264
    v_xor_b32 v4, 0x40, v15
    ds_read_b128 v[164:167], v4 offset:0
    ds_read_b128 v[180:183], v4 offset:4096
    ds_read_b128 v[196:199], v4 offset:8192
    ds_read_b128 v[212:215], v4 offset:12288
    s_waitcnt lgkmcnt(4)
    v_mfma_f32_16x16x32_bf16 v[48:51], v[16:19], v[160:163], 0
    v_mfma_f32_16x16x32_bf16 v[52:55], v[20:23], v[160:163], 0
    s_waitcnt vmcnt(4)
    ds_read_b64_tr_b16 v[24:25], v14 offset:2048
    ds_read_b64_tr_b16 v[26:27], v14 offset:2304
    ds_read_b64_tr_b16 v[28:29], v14 offset:2056
    ds_read_b64_tr_b16 v[30:31], v14 offset:2312
    v_xor_b32 v4, 0x80, v15
    ds_read_b128 v[168:171], v4 offset:0
    ds_read_b128 v[184:187], v4 offset:4096
    ds_read_b128 v[200:203], v4 offset:8192
    ds_read_b128 v[216:219], v4 offset:12288
    v_mfma_f32_16x16x32_bf16 v[56:59], v[16:19], v[176:179], 0
    v_mfma_f32_16x16x32_bf16 v[60:63], v[20:23], v[176:179], 0
    v_mfma_f32_16x16x32_bf16 v[64:67], v[16:19], v[192:195], 0
    v_mfma_f32_16x16x32_bf16 v[68:71], v[20:23], v[192:195], 0
    v_mfma_f32_16x16x32_bf16 v[72:75], v[16:19], v[208:211], 0
    v_mfma_f32_16x16x32_bf16 v[76:79], v[20:23], v[208:211], 0
    s_waitcnt lgkmcnt(4)
    v_mfma_f32_16x16x32_bf16 v[48:51], v[24:27], v[164:167], v[48:51]
    v_mfma_f32_16x16x32_bf16 v[52:55], v[28:31], v[164:167], v[52:55]
    s_waitcnt vmcnt(2)
    ds_read_b64_tr_b16 v[32:33], v14 offset:4096
    ds_read_b64_tr_b16 v[34:35], v14 offset:4352
    ds_read_b64_tr_b16 v[36:37], v14 offset:4104
    ds_read_b64_tr_b16 v[38:39], v14 offset:4360
    v_xor_b32 v4, 0xc0, v15
    ds_read_b128 v[172:175], v4 offset:0
    ds_read_b128 v[188:191], v4 offset:4096
    ds_read_b128 v[204:207], v4 offset:8192
    ds_read_b128 v[220:223], v4 offset:12288
    v_mfma_f32_16x16x32_bf16 v[56:59], v[24:27], v[180:183], v[56:59]
    v_mfma_f32_16x16x32_bf16 v[60:63], v[28:31], v[180:183], v[60:63]
    v_mfma_f32_16x16x32_bf16 v[64:67], v[24:27], v[196:199], v[64:67]
    v_mfma_f32_16x16x32_bf16 v[68:71], v[28:31], v[196:199], v[68:71]
    v_mfma_f32_16x16x32_bf16 v[72:75], v[24:27], v[212:215], v[72:75]
    v_mfma_f32_16x16x32_bf16 v[76:79], v[28:31], v[212:215], v[76:79]
    s_waitcnt lgkmcnt(4)
    v_mfma_f32_16x16x32_bf16 v[48:51], v[32:35], v[168:171], v[48:51]
    v_mfma_f32_16x16x32_bf16 v[52:55], v[36:39], v[168:171], v[52:55]
    s_waitcnt vmcnt(0)
    ds_read_b64_tr_b16 v[40:41], v14 offset:6144
    ds_read_b64_tr_b16 v[42:43], v14 offset:6400
    ds_read_b64_tr_b16 v[44:45], v14 offset:6152
    ds_read_b64_tr_b16 v[46:47], v14 offset:6408
    v_mfma_f32_16x16x32_bf16 v[56:59], v[32:35], v[184:187], v[56:59]
    v_mfma_f32_16x16x32_bf16 v[60:63], v[36:39], v[184:187], v[60:63]
    v_mfma_f32_16x16x32_bf16 v[64:67], v[32:35], v[200:203], v[64:67]
    v_mfma_f32_16x16x32_bf16 v[68:71], v[36:39], v[200:203], v[68:71]
    v_mfma_f32_16x16x32_bf16 v[72:75], v[32:35], v[216:219], v[72:75]
    v_mfma_f32_16x16x32_bf16 v[76:79], v[36:39], v[216:219], v[76:79]
    s_waitcnt lgkmcnt(0)
    v_mfma_f32_16x16x32_bf16 v[48:51], v[40:43], v[172:175], v[48:51]
    v_mfma_f32_16x16x32_bf16 v[52:55], v[44:47], v[172:175], v[52:55]
    v_mfma_f32_16x16x32_bf16 v[56:59], v[40:43], v[188:191], v[56:59]
    v_mfma_f32_16x16x32_bf16 v[60:63], v[44:47], v[188:191], v[60:63]
    v_mfma_f32_16x16x32_bf16 v[64:67], v[40:43], v[204:207], v[64:67]
    v_mfma_f32_16x16x32_bf16 v[68:71], v[44:47], v[204:207], v[68:71]
    v_mfma_f32_16x16x32_bf16 v[72:75], v[40:43], v[220:223], v[72:75]
    v_mfma_f32_16x16x32_bf16 v[76:79], v[44:47], v[220:223], v[76:79]
    buffer_load_dword v129, off, s[96:99], 0 offset:128 sc1
    s_add_u32 m0, s74, 132352
    s_lshl_b32 s3, s57, 8
    buffer_load_dwordx4 v145, s[40:43], s3 offen lds
    buffer_load_dwordx4 v146, s[40:43], s3 offen offset:1024 lds
    s_mov_b32 s36, s14
    s_mov_b32 s37, s15
    s_mov_b32 s38, 512
    s_mov_b32 s39, 0x00020000
    v_lshrrev_b32 v3, 4, v246
    v_lshlrev_b32 v4, 4, v3
    s_lshl_b32 s3, s56, 6
    buffer_load_dwordx4 v[116:119], v4, s[36:39], s3 offen
    v_lshlrev_b32 v5, 2, v0
    s_mov_b32 s3, 131072
    buffer_load_dword v128, v5, s[32:35], s3 offen
    v_lshlrev_b32 v4, 3, v3
    s_mov_b32 s36, s18
    s_mov_b32 s37, s19
    s_mov_b32 s38, 256
    s_lshl_b32 s3, s56, 5
    buffer_load_dwordx2 v[230:231], v4, s[36:39], s3 offen
    s_nop 4
    v_pk_mul_f32 v[48:49], v[48:49], v[12:13]
    v_pk_mul_f32 v[50:51], v[50:51], v[12:13]
    v_pk_mul_f32 v[52:53], v[52:53], v[12:13]
    v_pk_mul_f32 v[54:55], v[54:55], v[12:13]
    v_cvt_pk_bf16_f32 v148, v48, v49
    v_cvt_pk_bf16_f32 v149, v50, v51
    v_cvt_pk_bf16_f32 v150, v52, v53
    v_cvt_pk_bf16_f32 v151, v54, v55
    s_mov_b32 s3, 0
    buffer_store_dwordx4 v[148:151], v144, s[28:31], s3 offen sc0 sc1
    v_pk_mul_f32 v[56:57], v[56:57], v[12:13]
    v_pk_mul_f32 v[58:59], v[58:59], v[12:13]
    v_pk_mul_f32 v[60:61], v[60:61], v[12:13]
    v_pk_mul_f32 v[62:63], v[62:63], v[12:13]
    v_cvt_pk_bf16_f32 v152, v56, v57
    v_cvt_pk_bf16_f32 v153, v58, v59
    v_cvt_pk_bf16_f32 v154, v60, v61
    v_cvt_pk_bf16_f32 v155, v62, v63
    s_mov_b32 s3, 8192
    buffer_store_dwordx4 v[152:155], v144, s[28:31], s3 offen sc0 sc1
    v_pk_mul_f32 v[64:65], v[64:65], v[12:13]
    v_pk_mul_f32 v[66:67], v[66:67], v[12:13]
    v_pk_mul_f32 v[68:69], v[68:69], v[12:13]
    v_pk_mul_f32 v[70:71], v[70:71], v[12:13]
    v_cvt_pk_bf16_f32 v156, v64, v65
    v_cvt_pk_bf16_f32 v157, v66, v67
    v_cvt_pk_bf16_f32 v158, v68, v69
    v_cvt_pk_bf16_f32 v159, v70, v71
    v_pk_mul_f32 v[72:73], v[72:73], v[12:13]
    v_pk_mul_f32 v[74:75], v[74:75], v[12:13]
    v_pk_mul_f32 v[76:77], v[76:77], v[12:13]
    v_pk_mul_f32 v[78:79], v[78:79], v[12:13]
    v_cvt_pk_bf16_f32 v160, v72, v73
    v_cvt_pk_bf16_f32 v161, v74, v75
    v_cvt_pk_bf16_f32 v162, v76, v77
    v_cvt_pk_bf16_f32 v163, v78, v79
    s_add_u32 m0, s66, 0
    s_mov_b32 s77, 65536
    buffer_load_dwordx4 v10, s[32:35], s77 offen lds
    s_add_u32 m0, s66, 1024
    s_mov_b32 s77, 73728
    buffer_load_dwordx4 v10, s[32:35], s77 offen lds
    s_add_u32 m0, s66, 2048
    s_mov_b32 s77, 81920
    buffer_load_dwordx4 v10, s[32:35], s77 offen lds
    s_add_u32 m0, s66, 3072
    s_mov_b32 s77, 90112
    buffer_load_dwordx4 v10, s[32:35], s77 offen lds
    s_add_u32 m0, s66, 4096
    s_mov_b32 s77, 98304
    buffer_load_dwordx4 v10, s[32:35], s77 offen lds
    s_add_u32 m0, s66, 5120
    s_mov_b32 s77, 106496
    buffer_load_dwordx4 v10, s[32:35], s77 offen lds
    s_add_u32 m0, s66, 6144
    s_mov_b32 s77, 114688
    buffer_load_dwordx4 v10, s[32:35], s77 offen lds
    s_add_u32 m0, s66, 7168
    s_mov_b32 s77, 122880
    buffer_load_dwordx4 v10, s[32:35], s77 offen lds
    v_max3_f32 v8, |v48|, |v49|, |v50|
    v_max3_f32 v8, |v51|, |v52|, v8
    v_max3_f32 v8, |v53|, |v54|, v8
    v_max3_f32 v8, |v55|, |v56|, v8
    v_max3_f32 v8, |v57|, |v58|, v8
    v_max3_f32 v8, |v59|, |v60|, v8
    v_max3_f32 v8, |v61|, |v62|, v8
    v_max3_f32 v8, |v63|, |v64|, v8
    v_max3_f32 v8, |v65|, |v66|, v8
    v_max3_f32 v8, |v67|, |v68|, v8
    v_max3_f32 v8, |v69|, |v70|, v8
    v_max3_f32 v8, |v71|, |v72|, v8
    v_max3_f32 v8, |v73|, |v74|, v8
    v_max3_f32 v8, |v75|, |v76|, v8
    v_max3_f32 v8, |v77|, |v78|, v8
    v_max_f32 v8, |v79|, v8
    v_cmp_nge_f32 vcc, 0x40800000, v8
    s_or_b32 s3, vcc_lo, vcc_hi
    s_or_b32 s83, s83, s3
    s_waitcnt vmcnt(10)
M_join:
    s_mov_b32 s78, 80
    v_lshlrev_b32 v8, 16, v128
    v_and_b32 v9, 0xffff0000, v128
    v_mul_f32 v8, v12, v8
    v_mul_f32 v9, v12, v9
    v_cvt_pk_bf16_f32 v10, v8, v9
    v_lshrrev_b32 v4, 7, v0
    v_lshlrev_b32 v5, 16, v10
    v_and_b32 v6, 0xffff0000, v10
    v_sub_f32 v8, v8, v5
    v_sub_f32 v9, v9, v6
    v_cvt_pk_bf16_f32 v11, v8, v9
    v_lshlrev_b32 v5, 2, v0
    v_mad_u32_u24 v5, v4, s78, v5
    v_add_u32 v5, 111104, v5
    ds_write_b32 v5, v10
    ds_write_b32 v5, v11 offset:2368
    v_lshlrev_b32 v120, 16, v116
    v_and_b32 v121, 0xffff0000, v116
    v_lshlrev_b32 v122, 16, v117
    v_and_b32 v123, 0xffff0000, v117
    v_lshlrev_b32 v124, 16, v118
    v_and_b32 v125, 0xffff0000, v118
    v_lshlrev_b32 v126, 16, v119
    v_and_b32 v127, 0xffff0000, v119
    v_and_b32 v8, 15, v246
    v_lshrrev_b32 v9, 4, v246
    v_bfe_u32 v4, v8, 1, 2
    v_xor_b32 v4, v4, v9
    v_lshlrev_b32 v4, 4, v4
    v_lshl_add_u32 v254, v8, 6, v4
    v_add_u32 v4, s57, v8
    v_lshlrev_b32 v4, 8, v4
    v_lshl_add_u32 v4, v9, 3, v4
    s_lshl_b32 s3, s56, 5
    v_add_u32 v255, s3, v4
    v_and_b32 v8, 31, v246
    v_lshrrev_b32 v9, 5, v246
    v_lshlrev_b32 v9, 1, v9
    v_bfe_u32 v4, v8, 1, 2
    v_xor_b32 v4, v4, v9
    v_lshlrev_b32 v4, 4, v4
    v_lshl_add_u32 v4, v8, 6, v4
    v_add_u32 v252, s66, v4
    v_xor_b32 v253, 16, v252
    s_cmp_lg_u32 s56, 0
    s_cbranch_scc1 M_w1d
    v_readfirstlane_b32 s3, v129
    s_cmp_lg_u32 s3, 0
    s_cbranch_scc1 M_pfda
    s_mov_b32 s71, 0x40000
M_spfa:
    s_mov_b32 s77, 0
    s_atomic_add s77, s[22:23], 128 glc
    s_sub_u32 s71, s71, 1
    s_cbranch_scc1 M_spdfa
    s_waitcnt lgkmcnt(0)
    s_cmp_lg_u32 s77, 1
    s_cbranch_scc1 M_spfa
M_spdfa:
    s_waitcnt lgkmcnt(0)
M_pfda:
    s_and_b32 s3, s2, 15
    s_lshl_b32 s3, s3, 7
    s_add_u32 s3, s3, 2048
    s_mov_b32 s71, 0x40000
M_spa:
    s_mov_b32 s77, 0
    s_atomic_add s77, s[24:25], s3 glc
    s_sub_u32 s71, s71, 1
    s_cbranch_scc1 M_spda
    s_waitcnt lgkmcnt(0)
    s_cmp_lg_u32 s77, 2
    s_cbranch_scc1 M_spa
M_spda:
    s_waitcnt lgkmcnt(0)
M_w1d:
    v_add_u32 v15, 132352, v147
    s_lshl_b32 s76, s2, 13
    s_add_u32 s76, s76, 73728
    v_lshlrev_b32 v1, 4, v0
    s_waitcnt lgkmcnt(0)
    s_barrier
    buffer_load_dwordx4 v[4:7], v1, s[44:47], s76 offen sc0 sc1
    s_barrier
    s_mov_b32 s3, 16384
    buffer_store_dwordx4 v[156:159], v144, s[28:31], s3 offen sc0 sc1
    s_mov_b32 s3, 24576
    buffer_store_dwordx4 v[160:163], v144, s[28:31], s3 offen sc0 sc1
    s_cmp_lg_u32 s83, 0
    s_cbranch_scc1 M_pbig
M_pbigr:
    ds_read_b128 v[176:179], v15 offset:0
    ds_read_b128 v[192:195], v15 offset:4096
    ds_read_b128 v[208:211], v15 offset:8192
    v_xor_b32 v8, 0x40, v15
    ds_read_b128 v[180:183], v8 offset:0
    ds_read_b128 v[196:199], v8 offset:4096
    ds_read_b128 v[212:215], v8 offset:8192
    v_xor_b32 v8, 0x80, v15
    ds_read_b128 v[184:187], v8 offset:0
    ds_read_b128 v[200:203], v8 offset:4096
    ds_read_b128 v[216:219], v8 offset:8192
    v_xor_b32 v8, 0xc0, v15
    ds_read_b128 v[188:191], v8 offset:0
    ds_read_b128 v[204:207], v8 offset:4096
    ds_read_b128 v[220:223], v8 offset:8192
    s_cmp_ge_u32 s2, 64
    s_cbranch_scc1 M_tk1a
    s_waitcnt vmcnt(3) lgkmcnt(0)
    s_branch M_tk1
M_tk1a:
    s_waitcnt vmcnt(3) lgkmcnt(0)
M_tk1:
    ds_read_b64_tr_b16 v[16:17], v14 offset:0
    ds_read_b64_tr_b16 v[18:19], v14 offset:256
    ds_read_b64_tr_b16 v[20:21], v14 offset:8
    ds_read_b64_tr_b16 v[22:23], v14 offset:264
    ds_read_b64_tr_b16 v[24:25], v14 offset:2048
    ds_read_b64_tr_b16 v[26:27], v14 offset:2304
    ds_read_b64_tr_b16 v[28:29], v14 offset:2056
    ds_read_b64_tr_b16 v[30:31], v14 offset:2312
    ds_read_b64_tr_b16 v[32:33], v14 offset:4096
    ds_read_b64_tr_b16 v[34:35], v14 offset:4352
    ds_read_b64_tr_b16 v[36:37], v14 offset:4104
    ds_read_b64_tr_b16 v[38:39], v14 offset:4360
    ds_read_b64_tr_b16 v[40:41], v14 offset:6144
    ds_read_b64_tr_b16 v[42:43], v14 offset:6400
    ds_read_b64_tr_b16 v[44:45], v14 offset:6152
    ds_read_b64_tr_b16 v[46:47], v14 offset:6408
    s_waitcnt lgkmcnt(12)
    v_mfma_f32_16x16x32_bf16 v[48:51], v[16:19], v[176:179], v[120:123]
    v_mfma_f32_16x16x32_bf16 v[52:55], v[20:23], v[176:179], v[124:127]
    v_mfma_f32_16x16x32_bf16 v[56:59], v[16:19], v[192:195], v[120:123]
    v_mfma_f32_16x16x32_bf16 v[60:63], v[20:23], v[192:195], v[124:127]
    v_mfma_f32_16x16x32_bf16 v[64:67], v[16:19], v[208:211], v[120:123]
    v_mfma_f32_16x16x32_bf16 v[68:71], v[20:23], v[208:211], v[124:127]
    s_waitcnt lgkmcnt(8)
    v_mfma_f32_16x16x32_bf16 v[48:51], v[24:27], v[180:183], v[48:51]
    v_mfma_f32_16x16x32_bf16 v[52:55], v[28:31], v[180:183], v[52:55]
    v_mfma_f32_16x16x32_bf16 v[56:59], v[24:27], v[196:199], v[56:59]
    v_mfma_f32_16x16x32_bf16 v[60:63], v[28:31], v[196:199], v[60:63]
    v_mfma_f32_16x16x32_bf16 v[64:67], v[24:27], v[212:215], v[64:67]
    v_mfma_f32_16x16x32_bf16 v[68:71], v[28:31], v[212:215], v[68:71]
    s_waitcnt lgkmcnt(4)
    v_mfma_f32_16x16x32_bf16 v[48:51], v[32:35], v[184:187], v[48:51]
    v_mfma_f32_16x16x32_bf16 v[52:55], v[36:39], v[184:187], v[52:55]
    v_mfma_f32_16x16x32_bf16 v[56:59], v[32:35], v[200:203], v[56:59]
    v_mfma_f32_16x16x32_bf16 v[60:63], v[36:39], v[200:203], v[60:63]
    v_mfma_f32_16x16x32_bf16 v[64:67], v[32:35], v[216:219], v[64:67]
    v_mfma_f32_16x16x32_bf16 v[68:71], v[36:39], v[216:219], v[68:71]
    s_waitcnt lgkmcnt(0)
    v_mfma_f32_16x16x32_bf16 v[48:51], v[40:43], v[188:191], v[48:51]
    v_mfma_f32_16x16x32_bf16 v[52:55], v[44:47], v[188:191], v[52:55]
    v_mfma_f32_16x16x32_bf16 v[56:59], v[40:43], v[204:207], v[56:59]
    v_mfma_f32_16x16x32_bf16 v[60:63], v[44:47], v[204:207], v[60:63]
    v_mfma_f32_16x16x32_bf16 v[64:67], v[40:43], v[220:223], v[64:67]
    v_mfma_f32_16x16x32_bf16 v[68:71], v[44:47], v[220:223], v[68:71]
    v_and_b32 v8, 15, v246
    v_lshrrev_b32 v9, 4, v246
    v_lshlrev_b32 v9, 4, v9
    v_mul_u32_u24 v8, 592, v8
    s_lshl_b32 s3, s56, 6
    s_add_u32 s3, s3, 115840
    v_add3_u32 v131, v8, v9, s3
    s_nop 4
    v_pk_mul_f32 v[48:49], v[48:49], v[12:13]
    v_pk_mul_f32 v[50:51], v[50:51], v[12:13]
    v_pk_mul_f32 v[52:53], v[52:53], v[12:13]
    v_pk_mul_f32 v[54:55], v[54:55], v[12:13]
    v_cvt_pk_bf16_f32 v164, v48, v49
    v_cvt_pk_bf16_f32 v165, v50, v51
    v_cvt_pk_bf16_f32 v166, v52, v53
    v_cvt_pk_bf16_f32 v167, v54, v55
    v_pk_mul_f32 v[56:57], v[56:57], v[12:13]
    v_pk_mul_f32 v[58:59], v[58:59], v[12:13]
    v_pk_mul_f32 v[60:61], v[60:61], v[12:13]
    v_pk_mul_f32 v[62:63], v[62:63], v[12:13]
    v_cvt_pk_bf16_f32 v168, v56, v57
    v_cvt_pk_bf16_f32 v169, v58, v59
    v_cvt_pk_bf16_f32 v170, v60, v61
    v_cvt_pk_bf16_f32 v171, v62, v63
    v_pk_mul_f32 v[64:65], v[64:65], v[12:13]
    v_pk_mul_f32 v[66:67], v[66:67], v[12:13]
    v_pk_mul_f32 v[68:69], v[68:69], v[12:13]
    v_pk_mul_f32 v[70:71], v[70:71], v[12:13]
    v_cvt_pk_bf16_f32 v172, v64, v65
    v_cvt_pk_bf16_f32 v173, v66, v67
    v_cvt_pk_bf16_f32 v174, v68, v69
    v_cvt_pk_bf16_f32 v175, v70, v71
    v_max3_f32 v8, |v48|, |v49|, |v50|
    v_max3_f32 v8, |v51|, |v52|, v8
    v_max3_f32 v8, |v53|, |v54|, v8
    v_max3_f32 v8, |v55|, |v56|, v8
    v_max3_f32 v8, |v57|, |v58|, v8
    v_max3_f32 v8, |v59|, |v60|, v8
    v_max3_f32 v8, |v61|, |v62|, v8
    v_max3_f32 v8, |v63|, |v64|, v8
    v_max3_f32 v8, |v65|, |v66|, v8
    v_max3_f32 v8, |v67|, |v68|, v8
    v_max3_f32 v8, |v69|, |v70|, v8
    v_max_f32 v8, |v71|, v8
    v_cmp_nge_f32 vcc, 0x40800000, v8
    s_or_b32 s3, vcc_lo, vcc_hi
    s_or_b32 s83, s83, s3
    s_waitcnt vmcnt(2)
M_recs:
    s_mov_b32 s76, 0xfff00000
    v_mov_b32 v1, 1
    v_cmp_gt_u32 s[86:87], s76, v4
    v_cmp_gt_u32 s[88:89], s76, v5
    v_cmp_gt_u32 s[90:91], s76, v6
    v_cmp_gt_u32 s[92:93], s76, v7
    v_lshrrev_b32 v24, 20, v4
    v_lshl_add_u32 v24, v24, 3, v245
    v_lshrrev_b32 v25, 20, v5
    v_lshl_add_u32 v25, v25, 3, v245
    v_lshrrev_b32 v26, 20, v6
    v_lshl_add_u32 v26, v26, 3, v245
    v_lshrrev_b32 v27, 20, v7
    v_lshl_add_u32 v27, v27, 3, v245
    s_mov_b64 exec, s[86:87]
    s_cbranch_execz M_r1_0
    v_lshrrev_b32 v16, 12, v4
    v_subrev_u32 v16, s69, v16
    v_and_b32 v16, 0xfc, v16
    v_add_u32 v8, 110592, v16
    ds_add_rtn_u32 v20, v8, v1
    v_and_b32 v4, 0x3fff, v4
M_r1_0:
    s_mov_b64 exec, s[88:89]
    s_cbranch_execz M_r1_1
    v_lshrrev_b32 v17, 12, v5
    v_subrev_u32 v17, s69, v17
    v_and_b32 v17, 0xfc, v17
    v_add_u32 v8, 110592, v17
    ds_add_rtn_u32 v21, v8, v1
    v_and_b32 v5, 0x3fff, v5
M_r1_1:
    s_mov_b64 exec, s[90:91]
    s_cbranch_execz M_r1_2
    v_lshrrev_b32 v18, 12, v6
    v_subrev_u32 v18, s69, v18
    v_and_b32 v18, 0xfc, v18
    v_add_u32 v8, 110592, v18
    ds_add_rtn_u32 v22, v8, v1
    v_and_b32 v6, 0x3fff, v6
M_r1_2:
    s_mov_b64 exec, -1
    v_cmp_eq_u32 vcc, -2, v7
    s_and_b64 exec, exec, vcc
    s_cbranch_execz M_nomark
    v_mov_b32 v8, 110844
    v_mov_b32 v9, 0x10000
    ds_add_u32 v8, v9
M_nomark:
    s_mov_b64 exec, s[92:93]
    s_cbranch_execz M_r1_3
    v_lshrrev_b32 v19, 12, v7
    v_subrev_u32 v19, s69, v19
    v_and_b32 v19, 0xfc, v19
    v_add_u32 v8, 110592, v19
    ds_add_rtn_u32 v23, v8, v1
    v_and_b32 v7, 0x3fff, v7
M_r1_3:
    s_mov_b64 exec, -1
    s_mov_b32 s73, 0
    s_mov_b32 s67, 0
    v_lshlrev_b32 v9, 3, v246
    v_add_u32 v237, 92160, v9
    v_lshlrev_b32 v11, 2, v246
    v_add_u32 v11, 32, v11
    s_waitcnt vmcnt(0) lgkmcnt(0)
    s_barrier
    ds_read_b32 v8, v250
    v_mov_b32 v57, 0
    s_cmp_lg_u32 s56, 1
    s_cbranch_scc1 M_tk0
    s_cmp_lg_u32 s64, 0
    s_cbranch_scc1 M_tk0
    s_and_b32 s3, s2, 15
    s_lshl_b32 s3, s3, 7
    v_mov_b32 v57, 1
    s_mov_b64 exec, 1
    buffer_atomic_add v57, off, s[44:47], s3 sc0 sc1
    s_mov_b64 exec, -1
M_tk0:
    s_cmp_lg_u32 s64, 0
    s_cbranch_scc1 M_noq
    ds_write_b128 v131, v[164:167] offset:0
    ds_write_b128 v131, v[168:171] offset:9472
    ds_write_b128 v131, v[172:175] offset:18944
M_noq:
    v_mov_b32 v68, 0
    v_mov_b32 v69, 0
    v_mov_b32 v70, 0
    v_mov_b32 v71, 0
    v_mov_b32 v72, 0
    v_mov_b32 v73, 0
    v_mov_b32 v74, 0
    v_mov_b32 v75, 0
    v_mov_b32 v76, 0
    v_mov_b32 v77, 0
    v_mov_b32 v78, 0
    v_mov_b32 v79, 0
    v_mov_b32 v80, 0
    v_mov_b32 v81, 0
    v_mov_b32 v82, 0
    v_mov_b32 v83, 0
    s_waitcnt lgkmcnt(3)
    s_cmp_eq_u32 s64, 0
    s_cbranch_scc1 M_noq2
    s_waitcnt lgkmcnt(0)
M_noq2:
    v_add_u32 v9, 3, v8
    v_and_b32 v9, -4, v9
    v_mov_b32 v10, v9
    v_mov_b32 v64, 0
    v_mov_b32 v65, 0
    v_add_u32_dpp v10, v10, v10 row_shr:1 row_mask:0xf bank_mask:0xf bound_ctrl:0
    v_mov_b32 v66, 0
    v_mov_b32 v67, 0
    v_add_u32_dpp v10, v10, v10 row_shr:2 row_mask:0xf bank_mask:0xf bound_ctrl:0
    v_mov_b32 v128, 0
    v_mov_b32 v129, 0
    v_add_u32_dpp v10, v10, v10 row_shr:4 row_mask:0xf bank_mask:0xf bound_ctrl:0
    s_nop 1
    v_add_u32_dpp v10, v10, v10 row_shr:8 row_mask:0xf bank_mask:0xf bound_ctrl:0
    s_nop 1
    v_add_u32_dpp v10, v10, v10 row_bcast:15 row_mask:0xa bank_mask:0xf
    s_nop 1
    v_add_u32_dpp v10, v10, v10 row_bcast:31 row_mask:0xc bank_mask:0xf
    s_nop 0
    v_sub_u32 v243, v10, v9
    v_readlane_b32 s68, v10, 63
    s_cmp_lg_u32 s56, 1
    s_cbranch_scc1 M_derive
    s_waitcnt vmcnt(0)
    v_readfirstlane_b32 s3, v57
    s_cmp_lg_u32 s3, 15
    s_cbranch_scc1 M_derive
    s_mov_b32 s84, 1
    s_atomic_add s84, s[24:25], 4096
    s_atomic_add s84, s[24:25], 4224
    s_atomic_add s84, s[24:25], 4352
    s_atomic_add s84, s[24:25], 4480
    s_atomic_add s84, s[24:25], 4608
    s_atomic_add s84, s[24:25], 4736
    s_atomic_add s84, s[24:25], 4864
    s_atomic_add s84, s[24:25], 4992
    s_atomic_add s84, s[24:25], 5120
    s_atomic_add s84, s[24:25], 5248
    s_atomic_add s84, s[24:25], 5376
    s_atomic_add s84, s[24:25], 5504
    s_atomic_add s84, s[24:25], 5632
    s_atomic_add s84, s[24:25], 5760
    s_atomic_add s84, s[24:25], 5888
    s_atomic_add s84, s[24:25], 6016
M_derive:
    ds_bpermute_b32 v36, v16, v243
    ds_bpermute_b32 v37, v17, v243
    ds_bpermute_b32 v38, v18, v243
    ds_bpermute_b32 v39, v19, v243
    ds_bpermute_b32 v12, v11, v243
    s_cmp_gt_u32 s68, 832
    s_cbranch_scc1 M_goslow
    v_readlane_b32 s61, v243, 32
    s_add_u32 s60, s68, 31
    s_lshr_b32 s60, s60, 5
    v_add3_u32 v13, v243, v9, 63
    v_and_b32 v13, 0xffffffc0, v13
    s_waitcnt lgkmcnt(0)
    v_cmp_gt_u32 vcc, v13, v12
    v_cmp_ne_u32 s[76:77], s68, v12
    s_andn2_b32 s77, vcc_lo, s73
    s_and_b32 s76, s76, s77
    s_cbranch_scc1 M_align
    v_mov_b32 v1, 0x3f80
    s_mov_b64 exec, s[86:87]
    s_cbranch_execz M_r2_0
    v_add_u32 v20, v20, v36
    v_lshlrev_b32 v9, 2, v20
    v_add_u32 v9, 106496, v9
    ds_write_b32 v9, v4
    v_and_b32 v9, 0x80, v16
    v_add_u32 v9, v9, v16
    v_bfe_u32 v10, v20, 2, 2
    v_add_lshl_u32 v9, v9, v10, 1
    v_lshrrev_b32 v10, 4, v20
    v_lshl_add_u32 v9, v10, 8, v9
    v_add_u32 v9, 92160, v9
    ds_write_b16 v9, v1
    v_lshrrev_b32 v9, 4, v20
    v_and_b32 v10, 63, v20
    v_and_b32 v9, -4, v9
    v_cmp_eq_u32 vcc, 0, v10
    v_add_u32 v40, 110848, v9
    s_and_b64 exec, exec, vcc
    ds_write_b32 v40, v16
M_r2_0:
    s_mov_b64 exec, s[88:89]
    s_cbranch_execz M_r2_1
    v_add_u32 v21, v21, v37
    v_lshlrev_b32 v9, 2, v21
    v_add_u32 v9, 106496, v9
    ds_write_b32 v9, v5
    v_and_b32 v9, 0x80, v17
    v_add_u32 v9, v9, v17
    v_bfe_u32 v10, v21, 2, 2
    v_add_lshl_u32 v9, v9, v10, 1
    v_lshrrev_b32 v10, 4, v21
    v_lshl_add_u32 v9, v10, 8, v9
    v_add_u32 v9, 92160, v9
    ds_write_b16 v9, v1
    v_lshrrev_b32 v9, 4, v21
    v_and_b32 v10, 63, v21
    v_and_b32 v9, -4, v9
    v_cmp_eq_u32 vcc, 0, v10
    v_add_u32 v41, 110848, v9
    s_and_b64 exec, exec, vcc
    ds_write_b32 v41, v17
M_r2_1:
    s_mov_b64 exec, s[90:91]
    s_cbranch_execz M_r2_2
    v_add_u32 v22, v22, v38
    v_lshlrev_b32 v9, 2, v22
    v_add_u32 v9, 106496, v9
    ds_write_b32 v9, v6
    v_and_b32 v9, 0x80, v18
    v_add_u32 v9, v9, v18
    v_bfe_u32 v10, v22, 2, 2
    v_add_lshl_u32 v9, v9, v10, 1
    v_lshrrev_b32 v10, 4, v22
    v_lshl_add_u32 v9, v10, 8, v9
    v_add_u32 v9, 92160, v9
    ds_write_b16 v9, v1
    v_lshrrev_b32 v9, 4, v22
    v_and_b32 v10, 63, v22
    v_and_b32 v9, -4, v9
    v_cmp_eq_u32 vcc, 0, v10
    v_add_u32 v42, 110848, v9
    s_and_b64 exec, exec, vcc
    ds_write_b32 v42, v18
M_r2_2:
    s_mov_b64 exec, s[92:93]
    s_cbranch_execz M_r2_3
    v_add_u32 v23, v23, v39
    v_lshlrev_b32 v9, 2, v23
    v_add_u32 v9, 106496, v9
    ds_write_b32 v9, v7
    v_and_b32 v9, 0x80, v19
    v_add_u32 v9, v9, v19
    v_bfe_u32 v10, v23, 2, 2
    v_add_lshl_u32 v9, v9, v10, 1
    v_lshrrev_b32 v10, 4, v23
    v_lshl_add_u32 v9, v10, 8, v9
    v_add_u32 v9, 92160, v9
    ds_write_b16 v9, v1
    v_lshrrev_b32 v9, 4, v23
    v_and_b32 v10, 63, v23
    v_and_b32 v9, -4, v9
    v_cmp_eq_u32 vcc, 0, v10
    v_add_u32 v43, 110848, v9
    s_and_b64 exec, exec, vcc
    ds_write_b32 v43, v19
M_r2_3:
    s_mov_b64 exec, s[86:87]
    buffer_load_dwordx2 v[28:29], v24, s[52:55], 0 offen
    s_mov_b64 exec, s[88:89]
    buffer_load_dwordx2 v[30:31], v25, s[52:55], 0 offen
    s_mov_b64 exec, s[90:91]
    buffer_load_dwordx2 v[32:33], v26, s[52:55], 0 offen
    s_mov_b64 exec, s[92:93]
    buffer_load_dwordx2 v[34:35], v27, s[52:55], 0 offen
    s_mov_b64 exec, -1
    s_cmp_lt_u32 s61, s68
    s_cselect_b32 s76, 5, 31
    s_cselect_b32 s77, 1, 0x7fffffff
    s_lshr_b32 s61, s61, s76
    s_add_u32 s61, s61, s77
    v_add_u32 v244, v244, v8
    s_mul_i32 s72, s60, 21
    s_lshr_b32 s72, s72, 5
    s_cmp_lt_u32 s56, 4
    s_cselect_b32 s72, 0x7fffffff, s72
    s_sub_u32 s63, s60, 1
    s_min_i32 s63, s63, s61
    s_min_i32 s63, s63, s72
    v_mov_b32 v1, 0x3f80
    v_mov_b32 v56, 110848
    v_mov_b32 v130, 0
    v_mov_b32 v131, 0
    s_waitcnt lgkmcnt(0)
    s_barrier
    ds_read_b32 v36, v40
    ds_read_b32 v37, v41
    ds_read_b32 v38, v42
    ds_read_b32 v39, v43
    ds_read_b128 v[144:147], v56 offset:0
    ds_read_b128 v[148:151], v56 offset:16
    ds_read_b128 v[152:155], v56 offset:32
    ds_read_b128 v[156:159], v56 offset:48
    ds_read_b64 v[176:177], v238 offset:0
    ds_read_b64 v[178:179], v238 offset:128
    ds_read_b64 v[180:181], v238 offset:256
    ds_read_b64 v[182:183], v238 offset:384
    ds_read_b64 v[184:185], v238 offset:512
    ds_read_b64 v[186:187], v238 offset:640
    s_waitcnt lgkmcnt(5)
    v_lshl_add_u32 v176, v176, 9, v232
    v_lshl_add_u32 v177, v177, 9, v233
    s_waitcnt lgkmcnt(4)
    v_lshl_add_u32 v178, v178, 9, v234
    v_lshl_add_u32 v179, v179, 9, v235
    s_waitcnt lgkmcnt(3)
    v_lshl_add_u32 v180, v180, 9, v232
    v_lshl_add_u32 v181, v181, 9, v233
    s_waitcnt lgkmcnt(2)
    v_lshl_add_u32 v182, v182, 9, v234
    v_lshl_add_u32 v183, v183, 9, v235
    s_waitcnt lgkmcnt(1)
    v_lshl_add_u32 v184, v184, 9, v232
    v_lshl_add_u32 v185, v185, 9, v233
    s_waitcnt lgkmcnt(0)
    v_lshl_add_u32 v186, v186, 9, v234
    v_lshl_add_u32 v187, v187, 9, v235
    s_mov_b32 s85, 16
    s_cmp_lg_u32 s56, 0
    s_cbranch_scc1 M_nolook
    s_and_b32 s3, s2, 15
    s_lshl_b32 s3, s3, 7
    s_add_u32 s3, s3, 4096
    s_mov_b32 s85, 0
    s_atomic_add s85, s[24:25], s3 glc
M_nolook:
    s_waitcnt vmcnt(0)
    v_mov_b32 v59, 0
    s_mov_b64 exec, s[86:87]
    s_cbranch_execz M_r3_0
    v_lshlrev_b32 v8, 4, v20
    v_add_u32 v8, 65536, v8
    ds_write2_b64 v8, v[28:29], v[28:29] offset0:0 offset1:1
    v_sub_u32 v9, v16, v36
    v_lshrrev_b32 v9, 1, v9
    v_add_u32 v9, v9, v8
    ds_write_b16 v9, v1 offset:13312
    v_and_b32 v8, 0x7fff7fff, v28
    v_and_b32 v9, 0x7fff7fff, v29
    v_pk_max_u16 v8, v8, v9
    v_pk_max_u16 v59, v59, v8
M_r3_0:
    s_mov_b64 exec, s[88:89]
    s_cbranch_execz M_r3_1
    v_lshlrev_b32 v8, 4, v21
    v_add_u32 v8, 65536, v8
    ds_write2_b64 v8, v[30:31], v[30:31] offset0:0 offset1:1
    v_sub_u32 v9, v17, v37
    v_lshrrev_b32 v9, 1, v9
    v_add_u32 v9, v9, v8
    ds_write_b16 v9, v1 offset:13312
    v_and_b32 v8, 0x7fff7fff, v30
    v_and_b32 v9, 0x7fff7fff, v31
    v_pk_max_u16 v8, v8, v9
    v_pk_max_u16 v59, v59, v8
M_r3_1:
    s_mov_b64 exec, s[90:91]
    s_cbranch_execz M_r3_2
    v_lshlrev_b32 v8, 4, v22
    v_add_u32 v8, 65536, v8
    ds_write2_b64 v8, v[32:33], v[32:33] offset0:0 offset1:1
    v_sub_u32 v9, v18, v38
    v_lshrrev_b32 v9, 1, v9
    v_add_u32 v9, v9, v8
    ds_write_b16 v9, v1 offset:13312
    v_and_b32 v8, 0x7fff7fff, v32
    v_and_b32 v9, 0x7fff7fff, v33
    v_pk_max_u16 v8, v8, v9
    v_pk_max_u16 v59, v59, v8
M_r3_2:
    s_mov_b64 exec, s[92:93]
    s_cbranch_execz M_r3_3
    v_lshlrev_b32 v8, 4, v23
    v_add_u32 v8, 65536, v8
    ds_write2_b64 v8, v[34:35], v[34:35] offset0:0 offset1:1
    v_sub_u32 v9, v19, v39
    v_lshrrev_b32 v9, 1, v9
    v_add_u32 v9, v9, v8
    ds_write_b16 v9, v1 offset:13312
    v_and_b32 v8, 0x7fff7fff, v34
    v_and_b32 v9, 0x7fff7fff, v35
    v_pk_max_u16 v8, v8, v9
    v_pk_max_u16 v59, v59, v8
M_r3_3:
    s_mov_b64 exec, -1
    v_lshlrev_b32 v8, 16, v59
    v_and_b32 v59, 0xffff0000, v59
    v_max_u32 v59, v59, v8
    s_mov_b32 m0, s66
    v_mov_b32 v9, 111096
    v_max_u32_dpp v59, v59, v59 row_shr:1 row_mask:0xf bank_mask:0xf bound_ctrl:0
    s_nop 1
    v_max_u32_dpp v59, v59, v59 row_shr:2 row_mask:0xf bank_mask:0xf bound_ctrl:0
    s_nop 1
    v_max_u32_dpp v59, v59, v59 row_shr:4 row_mask:0xf bank_mask:0xf bound_ctrl:0
    s_nop 1
    v_max_u32_dpp v59, v59, v59 row_shr:8 row_mask:0xf bank_mask:0xf bound_ctrl:0
    s_waitcnt lgkmcnt(0)
    s_and_b32 s3, s85, 0xffff
    s_cmp_eq_u32 s3, 16
    s_cbranch_scc1 M_w2
    s_and_b32 s3, s2, 15
    s_lshl_b32 s3, s3, 7
    s_add_u32 s3, s3, 4096
    s_mov_b32 s71, 0x40000
M_spb:
    s_mov_b32 s77, 0
    s_atomic_add s77, s[24:25], s3 glc
    s_sub_u32 s71, s71, 1
    s_cbranch_scc1 M_spdb
    s_waitcnt lgkmcnt(0)
    s_mov_b32 s85, s77
    s_and_b32 s77, s77, 0xffff
    s_cmp_lg_u32 s77, 16
    s_cbranch_scc1 M_spb
M_spdb:
    s_waitcnt lgkmcnt(0)
M_w2:
    s_cmp_lt_u32 s85, 0x10000
    s_cbranch_scc1 M_w3
    v_mov_b32 v59, 0x7f800000
M_w3:
    s_mov_b32 exec_lo, 0x80008000
    s_mov_b32 exec_hi, 0x80008000
    ds_max_u32 v9, v59
    s_mov_b64 exec, -1
    s_waitcnt lgkmcnt(0)
    s_barrier
    s_cmp_eq_u32 s60, 0
    s_cbranch_scc1 M_empty
    buffer_load_dwordx4 v176, s[48:51], 0 offen offset:0  lds
    buffer_load_dwordx4 v177, s[48:51], 0 offen offset:1024  lds
    v_mov_b32 v9, 111096
    ds_read_b32 v59, v9
    ds_read_b64 v[188:189], v238 offset:768
    ds_read_b64 v[190:191], v238 offset:896
    ds_read_b64 v[192:193], v238 offset:1024
    ds_read_b64 v[194:195], v238 offset:1152
    ds_read_b64 v[196:197], v238 offset:1280
    ds_read_b64 v[198:199], v238 offset:1408
    ds_read_b64 v[200:201], v238 offset:1536
    ds_read_b64 v[202:203], v238 offset:1664
    ds_read_b64 v[204:205], v238 offset:1792
    ds_read_b64 v[206:207], v238 offset:1920
    v_mad_u32_u24 v144, v144, v242, v241
    v_mad_u32_u24 v145, v145, v242, v241
    v_mad_u32_u24 v146, v146, v242, v241
    v_mad_u32_u24 v147, v147, v242, v241
    v_mad_u32_u24 v148, v148, v242, v241
    v_mad_u32_u24 v149, v149, v242, v241
    v_mad_u32_u24 v150, v150, v242, v241
    v_mad_u32_u24 v151, v151, v242, v241
    v_mad_u32_u24 v152, v152, v242, v241
    v_mad_u32_u24 v153, v153, v242, v241
    v_mad_u32_u24 v154, v154, v242, v241
    v_mad_u32_u24 v155, v155, v242, v241
    v_mad_u32_u24 v156, v156, v242, v241
    ds_read_b64_tr_b16 v[132:133], v144
    ds_read_b64_tr_b16 v[134:135], v144 offset:2368
    ds_read_b128 v[124:127], v236
    s_barrier
    buffer_load_dwordx4 v178, s[48:51], 0 offen offset:2048  lds
    buffer_load_dwordx4 v179, s[48:51], 0 offen offset:3072  lds
    s_mov_b32 m0, s70
    s_waitcnt lgkmcnt(3)
    ds_read_b64 v[208:209], v238 offset:2048
    ds_read_b64 v[210:211], v238 offset:2176
    ds_read_b64 v[212:213], v238 offset:2304
    ds_read_b64 v[214:215], v238 offset:2432
    ds_read_b64 v[216:217], v238 offset:2560
    ds_read_b64 v[218:219], v238 offset:2688
    ds_read_b64 v[220:221], v238 offset:2816
    ds_read_b64 v[222:223], v238 offset:2944
    ds_read_b64 v[224:225], v238 offset:3072
    ds_read_b64 v[226:227], v238 offset:3200
    v_lshl_add_u32 v188, v188, 9, v232
    v_lshl_add_u32 v189, v189, 9, v233
    v_lshl_add_u32 v190, v190, 9, v234
    v_lshl_add_u32 v191, v191, 9, v235
    v_lshl_add_u32 v192, v192, 9, v232
    v_lshl_add_u32 v193, v193, 9, v233
    v_lshl_add_u32 v194, v194, 9, v234
    v_lshl_add_u32 v195, v195, 9, v235
    v_lshl_add_u32 v196, v196, 9, v232
    v_lshl_add_u32 v197, v197, 9, v233
    v_lshl_add_u32 v198, v198, 9, v234
    v_lshl_add_u32 v199, v199, 9, v235
    v_lshl_add_u32 v200, v200, 9, v232
    v_lshl_add_u32 v201, v201, 9, v233
    v_lshl_add_u32 v202, v202, 9, v234
    v_lshl_add_u32 v203, v203, 9, v235
    v_lshl_add_u32 v204, v204, 9, v232
    v_lshl_add_u32 v205, v205, 9, v233
    v_lshl_add_u32 v206, v206, 9, v234
    v_lshl_add_u32 v207, v207, 9, v235
    s_waitcnt lgkmcnt(0)
    v_lshl_add_u32 v208, v208, 9, v232
    v_lshl_add_u32 v209, v209, 9, v233
    v_lshl_add_u32 v210, v210, 9, v234
    v_lshl_add_u32 v211, v211, 9, v235
    v_lshl_add_u32 v212, v212, 9, v232
    v_lshl_add_u32 v213, v213, 9, v233
    v_lshl_add_u32 v214, v214, 9, v234
    v_lshl_add_u32 v215, v215, 9, v235
    v_lshl_add_u32 v216, v216, 9, v232
    v_lshl_add_u32 v217, v217, 9, v233
    v_lshl_add_u32 v218, v218, 9, v234
    v_lshl_add_u32 v219, v219, 9, v235
    v_lshl_add_u32 v220, v220, 9, v232
    v_lshl_add_u32 v221, v221, 9, v233
    v_lshl_add_u32 v222, v222, 9, v234
    v_lshl_add_u32 v223, v223, 9, v235
    v_lshl_add_u32 v224, v224, 9, v232
    v_lshl_add_u32 v225, v225, 9, v233
    v_lshl_add_u32 v226, v226, 9, v234
    v_lshl_add_u32 v227, v227, 9, v235
    s_cmp_lt_u32 s56, 4
    s_cbranch_scc1 M_nopri
    s_setprio 1
M_nopri:
    v_lshlrev_b32 v8, 16, v132
    v_and_b32 v9, 0xffff0000, v132
    v_add_f32 v8, |v8|, |v9|
    v_lshlrev_b32 v9, 16, v133
    v_add_f32 v8, v8, |v9|
    v_and_b32 v9, 0xffff0000, v133
    v_add_f32 v8, v8, |v9|
    v_mul_f32 v8, v8, v59
    v_cmp_nge_f32 vcc, 0x41ae41e7, v8
    s_or_b32 s3, s83, s64
    s_or_b32 s82, s3, vcc_lo
    s_cmp_eq_u32 s82, 0
    s_mov_b32 s82, 0xa7317218
    s_cselect_b32 s3, 1.0, 0x27800000
    s_cselect_b32 s82, 0xbf317218, s82
    v_mov_b32 v228, s3
    v_mov_b32 v229, s3
    v_mfma_f32_32x32x16_bf16 v[16:31], v[124:127], v[132:135], 0
    ds_read_b128 v[124:127], v236 offset:512
    s_barrier
    buffer_load_dwordx4 v180, s[48:51], 0 offen offset:0  lds
    buffer_load_dwordx4 v181, s[48:51], 0 offen offset:1024  lds
    s_waitcnt vmcnt(4)
    ds_read_b128 v[116:119], v239
    ds_read_b128 v[120:123], v240
    s_waitcnt lgkmcnt(1)
    v_mfma_f32_32x32x16_bf16 v[16:31], v[116:119], v[136:139], v[16:31]
    s_waitcnt lgkmcnt(0)
    v_mfma_f32_32x32x16_bf16 v[16:31], v[120:123], v[140:143], v[16:31]
    s_cmp_eq_u32 s3, 1.0
    s_nop 9
    s_cbranch_scc0 M_safe
    .p2align 3
    s_waitcnt lgkmcnt(0)
    v_mfma_f32_32x32x16_bf16 v[32:47], v[124:127], v[132:135], 0
    v_exp_f32 v48, v16
    v_exp_f32 v49, v17
    v_exp_f32 v50, v18
    v_exp_f32 v51, v19
    v_exp_f32 v52, v20
    v_exp_f32 v53, v21
    v_exp_f32 v54, v22
    v_exp_f32 v55, v23
    v_exp_f32 v56, v24
    v_exp_f32 v57, v25
    v_exp_f32 v58, v26
    v_exp_f32 v59, v27
    v_exp_f32 v60, v28
    ds_read_b128 v[124:127], v236 offset:1024
    ds_read_b64_tr_b16 v[132:133], v145
    ds_read_b64_tr_b16 v[134:135], v145 offset:2368
    v_exp_f32 v61, v29
    v_exp_f32 v62, v30
    v_exp_f32 v63, v31
    buffer_load_dwordx4 v182, s[48:51], 0 offen offset:2048  lds
    buffer_load_dwordx4 v183, s[48:51], 0 offen offset:3072  lds
    s_mov_b32 m0, s66
    v_pk_fma_f32 v[20:21], v[20:21], v[48:49], v[20:21]
    v_pk_fma_f32 v[22:23], v[22:23], v[50:51], v[22:23]
    v_pk_add_f32 v[52:53], v[52:53], v[228:229]
    v_pk_add_f32 v[54:55], v[54:55], v[228:229]
    v_pk_fma_f32 v[28:29], v[28:29], v[56:57], v[28:29]
    v_pk_fma_f32 v[30:31], v[30:31], v[58:59], v[30:31]
    v_pk_add_f32 v[60:61], v[60:61], v[228:229]
    v_pk_add_f32 v[62:63], v[62:63], v[228:229]
    v_pk_fma_f32 v[16:17], v[16:17], v[52:53], v[20:21]
    v_pk_fma_f32 v[18:19], v[18:19], v[54:55], v[22:23]
    v_pk_fma_f32 v[48:49], v[48:49], v[52:53], v[52:53]
    v_pk_fma_f32 v[50:51], v[50:51], v[54:55], v[54:55]
    v_pk_fma_f32 v[24:25], v[24:25], v[60:61], v[28:29]
    v_pk_fma_f32 v[26:27], v[26:27], v[62:63], v[30:31]
    v_pk_fma_f32 v[56:57], v[56:57], v[60:61], v[60:61]
    v_pk_fma_f32 v[58:59], v[58:59], v[62:63], v[62:63]
    v_and_b32 v8, 15, v246
    v_lshlrev_b32 v9, 2, v8
    ds_bpermute_b32 v6, v9, v244
    ds_bpermute_b32 v7, v9, v244 offset:64
    ds_bpermute_b32 v14, v9, v244 offset:128
    v_lshlrev_b32 v116, 16, v230
    v_and_b32 v117, 0xffff0000, v230
    v_lshlrev_b32 v118, 16, v231
    v_and_b32 v119, 0xffff0000, v231
    s_lshl_b32 s3, s58, 8
    s_mov_b32 s28, s20
    s_mov_b32 s29, s21
    s_mov_b32 s30, s3
    s_mov_b32 s31, 0x00020000
    s_waitcnt lgkmcnt(0)
    v_cvt_f32_u32 v6, v6
    v_cvt_f32_u32 v7, v7
    v_cvt_f32_u32 v14, v14
    v_pk_mul_f32 v[2:3], v[116:117], v[6:7] op_sel:[0,0] op_sel_hi:[1,0]
    v_pk_mul_f32 v[4:5], v[118:119], v[6:7] op_sel:[0,0] op_sel_hi:[1,0]
    v_pk_mul_f32 v[10:11], v[116:117], v[6:7] op_sel:[0,1] op_sel_hi:[1,1]
    v_pk_mul_f32 v[12:13], v[118:119], v[6:7] op_sel:[0,1] op_sel_hi:[1,1]
    v_pk_mul_f32 v[172:173], v[116:117], v[14:15] op_sel:[0,0] op_sel_hi:[1,0]
    v_pk_mul_f32 v[174:175], v[118:119], v[14:15] op_sel:[0,0] op_sel_hi:[1,0]
    s_waitcnt vmcnt(4)
    ds_read_b128 v[116:119], v239 offset:2048
    ds_read_b128 v[120:123], v240 offset:2048
    buffer_load_dwordx4 v184, s[48:51], 0 offen offset:0  lds
    buffer_load_dwordx4 v185, s[48:51], 0 offen offset:1024  lds
    v_pk_mul_f32 v[24:25], v[24:25], v[48:49]
    v_pk_mul_f32 v[26:27], v[26:27], v[50:51]
    v_pk_fma_f32 v[16:17], v[16:17], v[56:57], v[24:25]
    s_cmp_le_i32 s63, 0
    v_pk_fma_f32 v[18:19], v[18:19], v[58:59], v[26:27]
    v_pk_mul_f32 v[48:49], v[48:49], v[56:57]
    v_pk_mul_f32 v[50:51], v[50:51], v[58:59]
    s_cbranch_scc1 M_evf0
M_evrf0:
    v_rcp_f32 v48, v48
    v_rcp_f32 v49, v49
    s_waitcnt lgkmcnt(0)
    v_mfma_f32_32x32x16_bf16 v[32:47], v[116:119], v[136:139], v[32:47]
    v_rcp_f32 v50, v50
    v_rcp_f32 v51, v51
    v_mfma_f32_32x32x16_bf16 v[32:47], v[120:123], v[140:143], v[32:47]
    buffer_load_dwordx4 v186, s[48:51], 0 offen offset:2048  lds
    buffer_load_dwordx4 v187, s[48:51], 0 offen offset:3072  lds
    v_pk_mul_f32 v[16:17], v[16:17], v[48:49]
    v_pk_mul_f32 v[18:19], v[18:19], v[50:51]
    v_cvt_pk_bf16_f32 v64, v16, v17
    v_cvt_pk_bf16_f32 v65, v18, v19
    s_nop 3
    s_waitcnt lgkmcnt(0)
    v_mfma_f32_32x32x16_bf16 v[16:31], v[124:127], v[132:135], 0
    v_exp_f32 v48, v32
    v_exp_f32 v49, v33
    v_exp_f32 v50, v34
    v_exp_f32 v51, v35
    v_exp_f32 v52, v36
    v_exp_f32 v53, v37
    v_exp_f32 v54, v38
    v_exp_f32 v55, v39
    v_exp_f32 v56, v40
    v_exp_f32 v57, v41
    v_exp_f32 v58, v42
    v_exp_f32 v59, v43
    v_exp_f32 v60, v44
    s_mov_b32 m0, s70
    ds_read_b128 v[124:127], v236 offset:1536
    ds_read2st64_b64 v[128:131], v237 offset0:0 offset1:1
    v_exp_f32 v61, v45
    v_exp_f32 v62, v46
    v_exp_f32 v63, v47
    v_pk_fma_f32 v[36:37], v[36:37], v[48:49], v[36:37]
    v_pk_fma_f32 v[38:39], v[38:39], v[50:51], v[38:39]
    v_pk_add_f32 v[52:53], v[52:53], v[228:229]
    v_pk_add_f32 v[54:55], v[54:55], v[228:229]
    v_pk_fma_f32 v[44:45], v[44:45], v[56:57], v[44:45]
    v_pk_fma_f32 v[46:47], v[46:47], v[58:59], v[46:47]
    v_pk_add_f32 v[60:61], v[60:61], v[228:229]
    v_pk_add_f32 v[62:63], v[62:63], v[228:229]
    v_pk_fma_f32 v[32:33], v[32:33], v[52:53], v[36:37]
    v_pk_fma_f32 v[34:35], v[34:35], v[54:55], v[38:39]
    v_pk_fma_f32 v[48:49], v[48:49], v[52:53], v[52:53]
    v_pk_fma_f32 v[50:51], v[50:51], v[54:55], v[54:55]
    v_pk_fma_f32 v[40:41], v[40:41], v[60:61], v[44:45]
    v_pk_fma_f32 v[42:43], v[42:43], v[62:63], v[46:47]
    v_pk_fma_f32 v[56:57], v[56:57], v[60:61], v[60:61]
    v_pk_fma_f32 v[58:59], v[58:59], v[62:63], v[62:63]
    s_waitcnt vmcnt(6)
    ds_read_b128 v[116:119], v239 offset:4096
    ds_read_b128 v[120:123], v240 offset:4096
    v_pk_mul_f32 v[40:41], v[40:41], v[48:49]
    v_pk_mul_f32 v[42:43], v[42:43], v[50:51]
    v_pk_fma_f32 v[32:33], v[32:33], v[56:57], v[40:41]
    s_cmp_le_i32 s63, 1
    v_pk_fma_f32 v[34:35], v[34:35], v[58:59], v[42:43]
    v_pk_mul_f32 v[48:49], v[48:49], v[56:57]
    v_pk_mul_f32 v[50:51], v[50:51], v[58:59]
    s_cbranch_scc1 M_evf1
M_evrf1:
    v_rcp_f32 v48, v48
    v_rcp_f32 v49, v49
    s_waitcnt lgkmcnt(0)
    v_mfma_f32_32x32x16_bf16 v[16:31], v[116:119], v[136:139], v[16:31]
    v_rcp_f32 v50, v50
    v_rcp_f32 v51, v51
    v_mfma_f32_32x32x16_bf16 v[16:31], v[120:123], v[140:143], v[16:31]
    buffer_load_dwordx4 v188, s[48:51], 0 offen offset:0  lds
    buffer_load_dwordx4 v189, s[48:51], 0 offen offset:1024  lds
    v_pk_mul_f32 v[32:33], v[32:33], v[48:49]
    v_pk_mul_f32 v[34:35], v[34:35], v[50:51]
    v_cvt_pk_bf16_f32 v66, v32, v33
    v_cvt_pk_bf16_f32 v67, v34, v35
    s_nop 3
    s_waitcnt lgkmcnt(0)
    v_mfma_f32_32x32x16_bf16 v[32:47], v[124:127], v[132:135], 0
    v_exp_f32 v48, v16
    v_exp_f32 v49, v17
    v_exp_f32 v50, v18
    v_exp_f32 v51, v19
    v_exp_f32 v52, v20
    v_exp_f32 v53, v21
    v_exp_f32 v54, v22
    v_exp_f32 v55, v23
    v_exp_f32 v56, v24
    v_exp_f32 v57, v25
    v_exp_f32 v58, v26
    v_exp_f32 v59, v27
    v_exp_f32 v60, v28
    ds_read_b128 v[124:127], v236 offset:2048
    ds_read_b64_tr_b16 v[132:133], v146
    ds_read_b64_tr_b16 v[134:135], v146 offset:2368
    v_exp_f32 v61, v29
    v_exp_f32 v62, v30
    v_exp_f32 v63, v31
    v_pk_fma_f32 v[20:21], v[20:21], v[48:49], v[20:21]
    v_pk_fma_f32 v[22:23], v[22:23], v[50:51], v[22:23]
    v_pk_add_f32 v[52:53], v[52:53], v[228:229]
    v_pk_add_f32 v[54:55], v[54:55], v[228:229]
    v_pk_fma_f32 v[28:29], v[28:29], v[56:57], v[28:29]
    v_pk_fma_f32 v[30:31], v[30:31], v[58:59], v[30:31]
    v_pk_add_f32 v[60:61], v[60:61], v[228:229]
    v_pk_add_f32 v[62:63], v[62:63], v[228:229]
    v_pk_fma_f32 v[16:17], v[16:17], v[52:53], v[20:21]
    v_pk_fma_f32 v[18:19], v[18:19], v[54:55], v[22:23]
    v_pk_fma_f32 v[48:49], v[48:49], v[52:53], v[52:53]
    v_pk_fma_f32 v[50:51], v[50:51], v[54:55], v[54:55]
    v_pk_fma_f32 v[24:25], v[24:25], v[60:61], v[28:29]
    v_pk_fma_f32 v[26:27], v[26:27], v[62:63], v[30:31]
    v_pk_fma_f32 v[56:57], v[56:57], v[60:61], v[60:61]
    v_pk_fma_f32 v[58:59], v[58:59], v[62:63], v[62:63]
    s_waitcnt vmcnt(6)
    ds_read_b128 v[116:119], v239 offset:6144
    ds_read_b128 v[120:123], v240 offset:6144
    v_pk_mul_f32 v[24:25], v[24:25], v[48:49]
    v_pk_mul_f32 v[26:27], v[26:27], v[50:51]
    v_pk_fma_f32 v[16:17], v[16:17], v[56:57], v[24:25]
    s_cmp_le_i32 s63, 2
    v_pk_fma_f32 v[18:19], v[18:19], v[58:59], v[26:27]
    v_pk_mul_f32 v[48:49], v[48:49], v[56:57]
    v_pk_mul_f32 v[50:51], v[50:51], v[58:59]
    s_cbranch_scc1 M_evf2
M_evrf2:
    v_mfma_f32_32x32x16_bf16 v[68:83], v[64:67], v[128:131], v[68:83]
    v_rcp_f32 v48, v48
    v_rcp_f32 v49, v49
    s_waitcnt lgkmcnt(0)
    v_mfma_f32_32x32x16_bf16 v[32:47], v[116:119], v[136:139], v[32:47]
    v_rcp_f32 v50, v50
    v_rcp_f32 v51, v51
    v_mfma_f32_32x32x16_bf16 v[32:47], v[120:123], v[140:143], v[32:47]
    buffer_load_dwordx4 v190, s[48:51], 0 offen offset:2048  lds
    buffer_load_dwordx4 v191, s[48:51], 0 offen offset:3072  lds
    s_waitcnt vmcnt(6)
    ds_read_b128 v[116:119], v239 offset:0
    ds_read_b128 v[120:123], v240 offset:0
    v_pk_mul_f32 v[16:17], v[16:17], v[48:49]
    v_pk_mul_f32 v[18:19], v[18:19], v[50:51]
    v_cvt_pk_bf16_f32 v64, v16, v17
    v_cvt_pk_bf16_f32 v65, v18, v19
    s_nop 3
    s_waitcnt lgkmcnt(0)
    v_mfma_f32_32x32x16_bf16 v[16:31], v[124:127], v[132:135], 0
    v_exp_f32 v48, v32
    v_exp_f32 v49, v33
    v_exp_f32 v50, v34
    v_exp_f32 v51, v35
    v_mfma_f32_32x32x16_bf16 v[16:31], v[116:119], v[136:139], v[16:31]
    v_exp_f32 v52, v36
    v_exp_f32 v53, v37
    v_exp_f32 v54, v38
    v_exp_f32 v55, v39
    v_mfma_f32_32x32x16_bf16 v[16:31], v[120:123], v[140:143], v[16:31]
    v_exp_f32 v56, v40
    v_exp_f32 v57, v41
    v_exp_f32 v58, v42
    v_exp_f32 v59, v43
    v_exp_f32 v60, v44
    s_mov_b32 m0, s66
    ds_read_b128 v[124:127], v236 offset:2560
    ds_read2st64_b64 v[128:131], v237 offset0:2 offset1:3
    v_exp_f32 v61, v45
    v_exp_f32 v62, v46
    v_exp_f32 v63, v47
    v_pk_fma_f32 v[36:37], v[36:37], v[48:49], v[36:37]
    v_pk_fma_f32 v[38:39], v[38:39], v[50:51], v[38:39]
    v_pk_add_f32 v[52:53], v[52:53], v[228:229]
    v_pk_add_f32 v[54:55], v[54:55], v[228:229]
    v_pk_fma_f32 v[44:45], v[44:45], v[56:57], v[44:45]
    v_pk_fma_f32 v[46:47], v[46:47], v[58:59], v[46:47]
    v_pk_add_f32 v[60:61], v[60:61], v[228:229]
    v_pk_add_f32 v[62:63], v[62:63], v[228:229]
    v_pk_fma_f32 v[32:33], v[32:33], v[52:53], v[36:37]
    v_pk_fma_f32 v[34:35], v[34:35], v[54:55], v[38:39]
    v_pk_fma_f32 v[48:49], v[48:49], v[52:53], v[52:53]
    v_pk_fma_f32 v[50:51], v[50:51], v[54:55], v[54:55]
    v_pk_fma_f32 v[40:41], v[40:41], v[60:61], v[44:45]
    v_pk_fma_f32 v[42:43], v[42:43], v[62:63], v[46:47]
    s_waitcnt vmcnt(4)
    ds_read_b128 v[116:119], v239 offset:2048
    ds_read_b128 v[120:123], v240 offset:2048
    buffer_load_dwordx4 v192, s[48:51], 0 offen offset:0  lds
    buffer_load_dwordx4 v193, s[48:51], 0 offen offset:1024  lds
    v_pk_fma_f32 v[56:57], v[56:57], v[60:61], v[60:61]
    v_pk_fma_f32 v[58:59], v[58:59], v[62:63], v[62:63]
    v_pk_mul_f32 v[40:41], v[40:41], v[48:49]
    v_pk_mul_f32 v[42:43], v[42:43], v[50:51]
    v_pk_fma_f32 v[32:33], v[32:33], v[56:57], v[40:41]
    s_cmp_le_i32 s63, 3
    v_pk_fma_f32 v[34:35], v[34:35], v[58:59], v[42:43]
    v_pk_mul_f32 v[48:49], v[48:49], v[56:57]
    v_pk_mul_f32 v[50:51], v[50:51], v[58:59]
    s_cbranch_scc1 M_evf3
M_evrf3:
    v_rcp_f32 v48, v48
    v_rcp_f32 v49, v49
    v_rcp_f32 v50, v50
    v_rcp_f32 v51, v51
    v_pk_mul_f32 v[32:33], v[32:33], v[48:49]
    v_pk_mul_f32 v[34:35], v[34:35], v[50:51]
    v_cvt_pk_bf16_f32 v66, v32, v33
    v_cvt_pk_bf16_f32 v67, v34, v35
    s_waitcnt lgkmcnt(0)
    v_mfma_f32_32x32x16_bf16 v[32:47], v[124:127], v[132:135], 0
    v_exp_f32 v48, v16
    v_exp_f32 v49, v17
    v_exp_f32 v50, v18
    v_exp_f32 v51, v19
    v_mfma_f32_32x32x16_bf16 v[32:47], v[116:119], v[136:139], v[32:47]
    v_exp_f32 v52, v20
    v_exp_f32 v53, v21
    v_exp_f32 v54, v22
    v_exp_f32 v55, v23
    v_mfma_f32_32x32x16_bf16 v[32:47], v[120:123], v[140:143], v[32:47]
    v_exp_f32 v56, v24
    v_exp_f32 v57, v25
    v_exp_f32 v58, v26
    v_exp_f32 v59, v27
    v_exp_f32 v60, v28
    ds_read_b128 v[124:127], v236 offset:3072
    ds_read_b64_tr_b16 v[132:133], v147
    ds_read_b64_tr_b16 v[134:135], v147 offset:2368
    v_exp_f32 v61, v29
    v_exp_f32 v62, v30
    v_exp_f32 v63, v31
    v_pk_fma_f32 v[20:21], v[20:21], v[48:49], v[20:21]
    v_pk_fma_f32 v[22:23], v[22:23], v[50:51], v[22:23]
    v_pk_add_f32 v[52:53], v[52:53], v[228:229]
    v_pk_add_f32 v[54:55], v[54:55], v[228:229]
    v_pk_fma_f32 v[28:29], v[28:29], v[56:57], v[28:29]
    v_pk_fma_f32 v[30:31], v[30:31], v[58:59], v[30:31]
    v_pk_add_f32 v[60:61], v[60:61], v[228:229]
    v_pk_add_f32 v[62:63], v[62:63], v[228:229]
    v_pk_fma_f32 v[16:17], v[16:17], v[52:53], v[20:21]
    v_pk_fma_f32 v[18:19], v[18:19], v[54:55], v[22:23]
    v_pk_fma_f32 v[48:49], v[48:49], v[52:53], v[52:53]
    v_pk_fma_f32 v[50:51], v[50:51], v[54:55], v[54:55]
    v_pk_fma_f32 v[24:25], v[24:25], v[60:61], v[28:29]
    v_pk_fma_f32 v[26:27], v[26:27], v[62:63], v[30:31]
    s_waitcnt vmcnt(4)
    ds_read_b128 v[116:119], v239 offset:4096
    ds_read_b128 v[120:123], v240 offset:4096
    buffer_load_dwordx4 v194, s[48:51], 0 offen offset:2048  lds
    buffer_load_dwordx4 v195, s[48:51], 0 offen offset:3072  lds
    v_pk_fma_f32 v[56:57], v[56:57], v[60:61], v[60:61]
    v_pk_fma_f32 v[58:59], v[58:59], v[62:63], v[62:63]
    v_pk_mul_f32 v[24:25], v[24:25], v[48:49]
    v_pk_mul_f32 v[26:27], v[26:27], v[50:51]
    v_pk_fma_f32 v[16:17], v[16:17], v[56:57], v[24:25]
    s_cmp_le_i32 s63, 4
    v_pk_fma_f32 v[18:19], v[18:19], v[58:59], v[26:27]
    v_pk_mul_f32 v[48:49], v[48:49], v[56:57]
    v_pk_mul_f32 v[50:51], v[50:51], v[58:59]
    s_cbranch_scc1 M_evf4
M_evrf4:
    v_mfma_f32_32x32x16_bf16 v[68:83], v[64:67], v[128:131], v[68:83]
    v_rcp_f32 v48, v48
    v_rcp_f32 v49, v49
    v_rcp_f32 v50, v50
    v_rcp_f32 v51, v51
    v_pk_mul_f32 v[16:17], v[16:17], v[48:49]
    v_pk_mul_f32 v[18:19], v[18:19], v[50:51]
    v_cvt_pk_bf16_f32 v64, v16, v17
    v_cvt_pk_bf16_f32 v65, v18, v19
    s_waitcnt vmcnt(4) lgkmcnt(0)
    v_mfma_f32_32x32x16_bf16 v[16:31], v[124:127], v[132:135], 0
    v_exp_f32 v48, v32
    v_exp_f32 v49, v33
    v_exp_f32 v50, v34
    v_exp_f32 v51, v35
    v_mfma_f32_32x32x16_bf16 v[16:31], v[116:119], v[136:139], v[16:31]
    v_exp_f32 v52, v36
    v_exp_f32 v53, v37
    v_exp_f32 v54, v38
    v_exp_f32 v55, v39
    v_mfma_f32_32x32x16_bf16 v[16:31], v[120:123], v[140:143], v[16:31]
    v_exp_f32 v56, v40
    v_exp_f32 v57, v41
    v_exp_f32 v58, v42
    v_exp_f32 v59, v43
    v_exp_f32 v60, v44
    s_mov_b32 m0, s70
    ds_read_b128 v[124:127], v236 offset:3584
    ds_read2st64_b64 v[128:131], v237 offset0:4 offset1:5
    ds_read_b128 v[116:119], v239 offset:6144
    ds_read_b128 v[120:123], v240 offset:6144
    v_exp_f32 v61, v45
    v_exp_f32 v62, v46
    v_exp_f32 v63, v47
    v_pk_fma_f32 v[36:37], v[36:37], v[48:49], v[36:37]
    v_pk_fma_f32 v[38:39], v[38:39], v[50:51], v[38:39]
    v_pk_add_f32 v[52:53], v[52:53], v[228:229]
    v_pk_add_f32 v[54:55], v[54:55], v[228:229]
    v_pk_fma_f32 v[44:45], v[44:45], v[56:57], v[44:45]
    v_pk_fma_f32 v[46:47], v[46:47], v[58:59], v[46:47]
    v_pk_add_f32 v[60:61], v[60:61], v[228:229]
    buffer_load_dwordx4 v196, s[48:51], 0 offen offset:0  lds
    buffer_load_dwordx4 v197, s[48:51], 0 offen offset:1024  lds
    v_pk_add_f32 v[62:63], v[62:63], v[228:229]
    v_pk_fma_f32 v[32:33], v[32:33], v[52:53], v[36:37]
    v_pk_fma_f32 v[34:35], v[34:35], v[54:55], v[38:39]
    v_pk_fma_f32 v[48:49], v[48:49], v[52:53], v[52:53]
    v_pk_fma_f32 v[50:51], v[50:51], v[54:55], v[54:55]
    v_pk_fma_f32 v[40:41], v[40:41], v[60:61], v[44:45]
    v_pk_fma_f32 v[42:43], v[42:43], v[62:63], v[46:47]
    v_pk_fma_f32 v[56:57], v[56:57], v[60:61], v[60:61]
    v_pk_fma_f32 v[58:59], v[58:59], v[62:63], v[62:63]
    v_pk_mul_f32 v[40:41], v[40:41], v[48:49]
    v_pk_mul_f32 v[42:43], v[42:43], v[50:51]
    v_pk_fma_f32 v[32:33], v[32:33], v[56:57], v[40:41]
    s_cmp_le_i32 s63, 5
    v_pk_fma_f32 v[34:35], v[34:35], v[58:59], v[42:43]
    v_pk_mul_f32 v[48:49], v[48:49], v[56:57]
    v_pk_mul_f32 v[50:51], v[50:51], v[58:59]
    s_cbranch_scc1 M_evf5
M_evrf5:
    v_rcp_f32 v48, v48
    v_rcp_f32 v49, v49
    v_rcp_f32 v50, v50
    v_rcp_f32 v51, v51
    v_pk_mul_f32 v[32:33], v[32:33], v[48:49]
    v_pk_mul_f32 v[34:35], v[34:35], v[50:51]
    v_cvt_pk_bf16_f32 v66, v32, v33
    v_cvt_pk_bf16_f32 v67, v34, v35
    s_waitcnt vmcnt(4) lgkmcnt(0)
    v_mfma_f32_32x32x16_bf16 v[32:47], v[124:127], v[132:135], 0
    v_exp_f32 v48, v16
    v_exp_f32 v49, v17
    v_exp_f32 v50, v18
    v_exp_f32 v51, v19
    v_mfma_f32_32x32x16_bf16 v[32:47], v[116:119], v[136:139], v[32:47]
    v_exp_f32 v52, v20
    v_exp_f32 v53, v21
    v_exp_f32 v54, v22
    v_exp_f32 v55, v23
    v_mfma_f32_32x32x16_bf16 v[32:47], v[120:123], v[140:143], v[32:47]
    v_exp_f32 v56, v24
    v_exp_f32 v57, v25
    v_exp_f32 v58, v26
    v_exp_f32 v59, v27
    v_exp_f32 v60, v28
    ds_read_b128 v[124:127], v236 offset:4096
    ds_read_b64_tr_b16 v[132:133], v148
    ds_read_b64_tr_b16 v[134:135], v148 offset:2368
    ds_read_b128 v[116:119], v239 offset:0
    ds_read_b128 v[120:123], v240 offset:0
    v_exp_f32 v61, v29
    v_exp_f32 v62, v30
    v_exp_f32 v63, v31
    v_pk_fma_f32 v[20:21], v[20:21], v[48:49], v[20:21]
    v_pk_fma_f32 v[22:23], v[22:23], v[50:51], v[22:23]
    v_pk_add_f32 v[52:53], v[52:53], v[228:229]
    v_pk_add_f32 v[54:55], v[54:55], v[228:229]
    v_pk_fma_f32 v[28:29], v[28:29], v[56:57], v[28:29]
    v_pk_fma_f32 v[30:31], v[30:31], v[58:59], v[30:31]
    v_pk_add_f32 v[60:61], v[60:61], v[228:229]
    buffer_load_dwordx4 v198, s[48:51], 0 offen offset:2048  lds
    buffer_load_dwordx4 v199, s[48:51], 0 offen offset:3072  lds
    v_pk_add_f32 v[62:63], v[62:63], v[228:229]
    v_pk_fma_f32 v[16:17], v[16:17], v[52:53], v[20:21]
    v_pk_fma_f32 v[18:19], v[18:19], v[54:55], v[22:23]
    v_pk_fma_f32 v[48:49], v[48:49], v[52:53], v[52:53]
    v_pk_fma_f32 v[50:51], v[50:51], v[54:55], v[54:55]
    v_pk_fma_f32 v[24:25], v[24:25], v[60:61], v[28:29]
    v_pk_fma_f32 v[26:27], v[26:27], v[62:63], v[30:31]
    v_pk_fma_f32 v[56:57], v[56:57], v[60:61], v[60:61]
    v_pk_fma_f32 v[58:59], v[58:59], v[62:63], v[62:63]
    v_pk_mul_f32 v[24:25], v[24:25], v[48:49]
    v_pk_mul_f32 v[26:27], v[26:27], v[50:51]
    v_pk_fma_f32 v[16:17], v[16:17], v[56:57], v[24:25]
    s_cmp_le_i32 s63, 6
    v_pk_fma_f32 v[18:19], v[18:19], v[58:59], v[26:27]
    v_pk_mul_f32 v[48:49], v[48:49], v[56:57]
    v_pk_mul_f32 v[50:51], v[50:51], v[58:59]
    s_cbranch_scc1 M_evf6
M_evrf6:
    v_mfma_f32_32x32x16_bf16 v[68:83], v[64:67], v[128:131], v[68:83]
    v_rcp_f32 v48, v48
    v_rcp_f32 v49, v49
    v_rcp_f32 v50, v50
    v_rcp_f32 v51, v51
    v_pk_mul_f32 v[16:17], v[16:17], v[48:49]
    v_pk_mul_f32 v[18:19], v[18:19], v[50:51]
    v_cvt_pk_bf16_f32 v64, v16, v17
    v_cvt_pk_bf16_f32 v65, v18, v19
    s_waitcnt vmcnt(4) lgkmcnt(0)
    v_mfma_f32_32x32x16_bf16 v[16:31], v[124:127], v[132:135], 0
    v_exp_f32 v48, v32
    v_exp_f32 v49, v33
    v_exp_f32 v50, v34
    v_exp_f32 v51, v35
    v_mfma_f32_32x32x16_bf16 v[16:31], v[116:119], v[136:139], v[16:31]
    v_exp_f32 v52, v36
    v_exp_f32 v53, v37
    v_exp_f32 v54, v38
    v_exp_f32 v55, v39
    v_mfma_f32_32x32x16_bf16 v[16:31], v[120:123], v[140:143], v[16:31]
    v_exp_f32 v56, v40
    v_exp_f32 v57, v41
    v_exp_f32 v58, v42
    v_exp_f32 v59, v43
    v_exp_f32 v60, v44
    s_mov_b32 m0, s66
    ds_read_b128 v[124:127], v236 offset:4608
    ds_read2st64_b64 v[128:131], v237 offset0:6 offset1:7
    ds_read_b128 v[116:119], v239 offset:2048
    ds_read_b128 v[120:123], v240 offset:2048
    v_exp_f32 v61, v45
    v_exp_f32 v62, v46
    v_exp_f32 v63, v47
    v_pk_fma_f32 v[36:37], v[36:37], v[48:49], v[36:37]
    v_pk_fma_f32 v[38:39], v[38:39], v[50:51], v[38:39]
    v_pk_add_f32 v[52:53], v[52:53], v[228:229]
    v_pk_add_f32 v[54:55], v[54:55], v[228:229]
    v_pk_fma_f32 v[44:45], v[44:45], v[56:57], v[44:45]
    v_pk_fma_f32 v[46:47], v[46:47], v[58:59], v[46:47]
    v_pk_add_f32 v[60:61], v[60:61], v[228:229]
    buffer_load_dwordx4 v200, s[48:51], 0 offen offset:0  lds
    buffer_load_dwordx4 v201, s[48:51], 0 offen offset:1024  lds
    v_pk_add_f32 v[62:63], v[62:63], v[228:229]
    v_pk_fma_f32 v[32:33], v[32:33], v[52:53], v[36:37]
    v_pk_fma_f32 v[34:35], v[34:35], v[54:55], v[38:39]
    v_pk_fma_f32 v[48:49], v[48:49], v[52:53], v[52:53]
    v_pk_fma_f32 v[50:51], v[50:51], v[54:55], v[54:55]
    v_pk_fma_f32 v[40:41], v[40:41], v[60:61], v[44:45]
    v_pk_fma_f32 v[42:43], v[42:43], v[62:63], v[46:47]
    v_pk_fma_f32 v[56:57], v[56:57], v[60:61], v[60:61]
    v_pk_fma_f32 v[58:59], v[58:59], v[62:63], v[62:63]
    v_pk_mul_f32 v[40:41], v[40:41], v[48:49]
    v_pk_mul_f32 v[42:43], v[42:43], v[50:51]
    v_pk_fma_f32 v[32:33], v[32:33], v[56:57], v[40:41]
    s_cmp_le_i32 s63, 7
    v_pk_fma_f32 v[34:35], v[34:35], v[58:59], v[42:43]
    v_pk_mul_f32 v[48:49], v[48:49], v[56:57]
    v_pk_mul_f32 v[50:51], v[50:51], v[58:59]
    s_cbranch_scc1 M_evf7
M_evrf7:
    v_rcp_f32 v48, v48
    v_rcp_f32 v49, v49
    v_rcp_f32 v50, v50
    v_rcp_f32 v51, v51
    v_pk_mul_f32 v[32:33], v[32:33], v[48:49]
    v_pk_mul_f32 v[34:35], v[34:35], v[50:51]
    v_cvt_pk_bf16_f32 v66, v32, v33
    v_cvt_pk_bf16_f32 v67, v34, v35
    s_waitcnt vmcnt(4) lgkmcnt(0)
    v_mfma_f32_32x32x16_bf16 v[32:47], v[124:127], v[132:135], 0
    v_exp_f32 v48, v16
    v_exp_f32 v49, v17
    v_exp_f32 v50, v18
    v_exp_f32 v51, v19
    v_mfma_f32_32x32x16_bf16 v[32:47], v[116:119], v[136:139], v[32:47]
    v_exp_f32 v52, v20
    v_exp_f32 v53, v21
    v_exp_f32 v54, v22
    v_exp_f32 v55, v23
    v_mfma_f32_32x32x16_bf16 v[32:47], v[120:123], v[140:143], v[32:47]
    v_exp_f32 v56, v24
    v_exp_f32 v57, v25
    v_exp_f32 v58, v26
    v_exp_f32 v59, v27
    v_exp_f32 v60, v28
    ds_read_b128 v[124:127], v236 offset:5120
    ds_read_b64_tr_b16 v[132:133], v149
    ds_read_b64_tr_b16 v[134:135], v149 offset:2368
    ds_read_b128 v[116:119], v239 offset:4096
    ds_read_b128 v[120:123], v240 offset:4096
    v_exp_f32 v61, v29
    v_exp_f32 v62, v30
    v_exp_f32 v63, v31
    v_pk_fma_f32 v[20:21], v[20:21], v[48:49], v[20:21]
    v_pk_fma_f32 v[22:23], v[22:23], v[50:51], v[22:23]
    v_pk_add_f32 v[52:53], v[52:53], v[228:229]
    v_pk_add_f32 v[54:55], v[54:55], v[228:229]
    v_pk_fma_f32 v[28:29], v[28:29], v[56:57], v[28:29]
    v_pk_fma_f32 v[30:31], v[30:31], v[58:59], v[30:31]
    v_pk_add_f32 v[60:61], v[60:61], v[228:229]
    buffer_load_dwordx4 v202, s[48:51], 0 offen offset:2048  lds
    buffer_load_dwordx4 v203, s[48:51], 0 offen offset:3072  lds
    buffer_load_dwordx4 v[176:179], v249, s[44:47], s26 offen offset:0 sc1
    v_pk_add_f32 v[62:63], v[62:63], v[228:229]
    v_pk_fma_f32 v[16:17], v[16:17], v[52:53], v[20:21]
    v_pk_fma_f32 v[18:19], v[18:19], v[54:55], v[22:23]
    v_pk_fma_f32 v[48:49], v[48:49], v[52:53], v[52:53]
    v_pk_fma_f32 v[50:51], v[50:51], v[54:55], v[54:55]
    v_pk_fma_f32 v[24:25], v[24:25], v[60:61], v[28:29]
    v_pk_fma_f32 v[26:27], v[26:27], v[62:63], v[30:31]
    v_pk_fma_f32 v[56:57], v[56:57], v[60:61], v[60:61]
    v_pk_fma_f32 v[58:59], v[58:59], v[62:63], v[62:63]
    v_pk_mul_f32 v[24:25], v[24:25], v[48:49]
    v_pk_mul_f32 v[26:27], v[26:27], v[50:51]
    v_pk_fma_f32 v[16:17], v[16:17], v[56:57], v[24:25]
    s_cmp_le_i32 s63, 8
    v_pk_fma_f32 v[18:19], v[18:19], v[58:59], v[26:27]
    v_pk_mul_f32 v[48:49], v[48:49], v[56:57]
    v_pk_mul_f32 v[50:51], v[50:51], v[58:59]
    s_cbranch_scc1 M_evf8
M_evrf8:
    v_mfma_f32_32x32x16_bf16 v[68:83], v[64:67], v[128:131], v[68:83]
    v_rcp_f32 v48, v48
    v_rcp_f32 v49, v49
    v_rcp_f32 v50, v50
    v_rcp_f32 v51, v51
    v_pk_mul_f32 v[16:17], v[16:17], v[48:49]
    v_pk_mul_f32 v[18:19], v[18:19], v[50:51]
    v_cvt_pk_bf16_f32 v64, v16, v17
    v_cvt_pk_bf16_f32 v65, v18, v19
    s_waitcnt vmcnt(5) lgkmcnt(0)
    v_mfma_f32_32x32x16_bf16 v[16:31], v[124:127], v[132:135], 0
    v_exp_f32 v48, v32
    v_exp_f32 v49, v33
    v_exp_f32 v50, v34
    v_exp_f32 v51, v35
    v_mfma_f32_32x32x16_bf16 v[16:31], v[116:119], v[136:139], v[16:31]
    v_exp_f32 v52, v36
    v_exp_f32 v53, v37
    v_exp_f32 v54, v38
    v_exp_f32 v55, v39
    v_mfma_f32_32x32x16_bf16 v[16:31], v[120:123], v[140:143], v[16:31]
    v_exp_f32 v56, v40
    v_exp_f32 v57, v41
    v_exp_f32 v58, v42
    v_exp_f32 v59, v43
    v_exp_f32 v60, v44
    s_mov_b32 m0, s70
    ds_read_b128 v[124:127], v236 offset:5632
    ds_read2st64_b64 v[128:131], v237 offset0:8 offset1:9
    ds_read_b128 v[116:119], v239 offset:6144
    ds_read_b128 v[120:123], v240 offset:6144
    v_exp_f32 v61, v45
    v_exp_f32 v62, v46
    v_exp_f32 v63, v47
    v_pk_fma_f32 v[36:37], v[36:37], v[48:49], v[36:37]
    v_pk_fma_f32 v[38:39], v[38:39], v[50:51], v[38:39]
    v_pk_add_f32 v[52:53], v[52:53], v[228:229]
    v_pk_add_f32 v[54:55], v[54:55], v[228:229]
    v_pk_fma_f32 v[44:45], v[44:45], v[56:57], v[44:45]
    v_pk_fma_f32 v[46:47], v[46:47], v[58:59], v[46:47]
    v_pk_add_f32 v[60:61], v[60:61], v[228:229]
    buffer_load_dwordx4 v204, s[48:51], 0 offen offset:0  lds
    buffer_load_dwordx4 v205, s[48:51], 0 offen offset:1024  lds
    buffer_load_dwordx4 v[180:183], v249, s[44:47], s26 offen offset:1024 sc1
    v_pk_add_f32 v[62:63], v[62:63], v[228:229]
    v_pk_fma_f32 v[32:33], v[32:33], v[52:53], v[36:37]
    v_pk_fma_f32 v[34:35], v[34:35], v[54:55], v[38:39]
    v_pk_fma_f32 v[48:49], v[48:49], v[52:53], v[52:53]
    v_pk_fma_f32 v[50:51], v[50:51], v[54:55], v[54:55]
    v_pk_fma_f32 v[40:41], v[40:41], v[60:61], v[44:45]
    v_pk_fma_f32 v[42:43], v[42:43], v[62:63], v[46:47]
    v_pk_fma_f32 v[56:57], v[56:57], v[60:61], v[60:61]
    v_pk_fma_f32 v[58:59], v[58:59], v[62:63], v[62:63]
    v_pk_mul_f32 v[40:41], v[40:41], v[48:49]
    v_pk_mul_f32 v[42:43], v[42:43], v[50:51]
    v_pk_fma_f32 v[32:33], v[32:33], v[56:57], v[40:41]
    s_cmp_le_i32 s63, 9
    v_pk_fma_f32 v[34:35], v[34:35], v[58:59], v[42:43]
    v_pk_mul_f32 v[48:49], v[48:49], v[56:57]
    v_pk_mul_f32 v[50:51], v[50:51], v[58:59]
    s_cbranch_scc1 M_evf9
M_evrf9:
    v_rcp_f32 v48, v48
    v_rcp_f32 v49, v49
    v_rcp_f32 v50, v50
    v_rcp_f32 v51, v51
    v_pk_mul_f32 v[32:33], v[32:33], v[48:49]
    v_pk_mul_f32 v[34:35], v[34:35], v[50:51]
    v_cvt_pk_bf16_f32 v66, v32, v33
    v_cvt_pk_bf16_f32 v67, v34, v35
    s_waitcnt vmcnt(6) lgkmcnt(0)
    v_mfma_f32_32x32x16_bf16 v[32:47], v[124:127], v[132:135], 0
    v_exp_f32 v48, v16
    v_exp_f32 v49, v17
    v_exp_f32 v50, v18
    v_exp_f32 v51, v19
    v_mfma_f32_32x32x16_bf16 v[32:47], v[116:119], v[136:139], v[32:47]
    v_exp_f32 v52, v20
    v_exp_f32 v53, v21
    v_exp_f32 v54, v22
    v_exp_f32 v55, v23
    v_mfma_f32_32x32x16_bf16 v[32:47], v[120:123], v[140:143], v[32:47]
    v_exp_f32 v56, v24
    v_exp_f32 v57, v25
    v_exp_f32 v58, v26
    v_exp_f32 v59, v27
    v_exp_f32 v60, v28
    ds_read_b128 v[124:127], v236 offset:6144
    ds_read_b64_tr_b16 v[132:133], v150
    ds_read_b64_tr_b16 v[134:135], v150 offset:2368
    ds_read_b128 v[116:119], v239 offset:0
    ds_read_b128 v[120:123], v240 offset:0
    v_exp_f32 v61, v29
    v_exp_f32 v62, v30
    v_exp_f32 v63, v31
    v_pk_fma_f32 v[20:21], v[20:21], v[48:49], v[20:21]
    v_pk_fma_f32 v[22:23], v[22:23], v[50:51], v[22:23]
    v_pk_add_f32 v[52:53], v[52:53], v[228:229]
    v_pk_add_f32 v[54:55], v[54:55], v[228:229]
    v_pk_fma_f32 v[28:29], v[28:29], v[56:57], v[28:29]
    v_pk_fma_f32 v[30:31], v[30:31], v[58:59], v[30:31]
    v_pk_add_f32 v[60:61], v[60:61], v[228:229]
    buffer_load_dwordx4 v206, s[48:51], 0 offen offset:2048  lds
    buffer_load_dwordx4 v207, s[48:51], 0 offen offset:3072  lds
    buffer_load_dwordx4 v[184:187], v249, s[44:47], s26 offen offset:2048 sc1
    v_pk_add_f32 v[62:63], v[62:63], v[228:229]
    v_pk_fma_f32 v[16:17], v[16:17], v[52:53], v[20:21]
    v_pk_fma_f32 v[18:19], v[18:19], v[54:55], v[22:23]
    v_pk_fma_f32 v[48:49], v[48:49], v[52:53], v[52:53]
    v_pk_fma_f32 v[50:51], v[50:51], v[54:55], v[54:55]
    v_pk_fma_f32 v[24:25], v[24:25], v[60:61], v[28:29]
    v_pk_fma_f32 v[26:27], v[26:27], v[62:63], v[30:31]
    v_pk_fma_f32 v[56:57], v[56:57], v[60:61], v[60:61]
    v_pk_fma_f32 v[58:59], v[58:59], v[62:63], v[62:63]
    v_pk_mul_f32 v[24:25], v[24:25], v[48:49]
    v_pk_mul_f32 v[26:27], v[26:27], v[50:51]
    v_pk_fma_f32 v[16:17], v[16:17], v[56:57], v[24:25]
    s_cmp_le_i32 s63, 10
    v_pk_fma_f32 v[18:19], v[18:19], v[58:59], v[26:27]
    v_pk_mul_f32 v[48:49], v[48:49], v[56:57]
    v_pk_mul_f32 v[50:51], v[50:51], v[58:59]
    s_cbranch_scc1 M_evf10
M_evrf10:
    v_mfma_f32_32x32x16_bf16 v[68:83], v[64:67], v[128:131], v[68:83]
    v_rcp_f32 v48, v48
    v_rcp_f32 v49, v49
    v_rcp_f32 v50, v50
    v_rcp_f32 v51, v51
    v_pk_mul_f32 v[16:17], v[16:17], v[48:49]
    v_pk_mul_f32 v[18:19], v[18:19], v[50:51]
    v_cvt_pk_bf16_f32 v64, v16, v17
    v_cvt_pk_bf16_f32 v65, v18, v19
    s_waitcnt vmcnt(7) lgkmcnt(0)
    v_mfma_f32_32x32x16_bf16 v[16:31], v[124:127], v[132:135], 0
    v_exp_f32 v48, v32
    v_exp_f32 v49, v33
    v_exp_f32 v50, v34
    v_exp_f32 v51, v35
    v_mfma_f32_32x32x16_bf16 v[16:31], v[116:119], v[136:139], v[16:31]
    v_exp_f32 v52, v36
    v_exp_f32 v53, v37
    v_exp_f32 v54, v38
    v_exp_f32 v55, v39
    v_mfma_f32_32x32x16_bf16 v[16:31], v[120:123], v[140:143], v[16:31]
    v_exp_f32 v56, v40
    v_exp_f32 v57, v41
    v_exp_f32 v58, v42
    v_exp_f32 v59, v43
    v_exp_f32 v60, v44
    s_mov_b32 m0, s66
    ds_read_b128 v[124:127], v236 offset:6656
    ds_read2st64_b64 v[128:131], v237 offset0:10 offset1:11
    ds_read_b128 v[116:119], v239 offset:2048
    ds_read_b128 v[120:123], v240 offset:2048
    v_exp_f32 v61, v45
    v_exp_f32 v62, v46
    v_exp_f32 v63, v47
    v_pk_fma_f32 v[36:37], v[36:37], v[48:49], v[36:37]
    v_pk_fma_f32 v[38:39], v[38:39], v[50:51], v[38:39]
    v_pk_add_f32 v[52:53], v[52:53], v[228:229]
    v_pk_add_f32 v[54:55], v[54:55], v[228:229]
    v_pk_fma_f32 v[44:45], v[44:45], v[56:57], v[44:45]
    v_pk_fma_f32 v[46:47], v[46:47], v[58:59], v[46:47]
    v_pk_add_f32 v[60:61], v[60:61], v[228:229]
    buffer_load_dwordx4 v208, s[48:51], 0 offen offset:0  lds
    buffer_load_dwordx4 v209, s[48:51], 0 offen offset:1024  lds
    buffer_load_dwordx4 v[188:191], v249, s[44:47], s26 offen offset:3072 sc1
    v_pk_add_f32 v[62:63], v[62:63], v[228:229]
    v_pk_fma_f32 v[32:33], v[32:33], v[52:53], v[36:37]
    v_pk_fma_f32 v[34:35], v[34:35], v[54:55], v[38:39]
    v_pk_fma_f32 v[48:49], v[48:49], v[52:53], v[52:53]
    v_pk_fma_f32 v[50:51], v[50:51], v[54:55], v[54:55]
    v_pk_fma_f32 v[40:41], v[40:41], v[60:61], v[44:45]
    v_pk_fma_f32 v[42:43], v[42:43], v[62:63], v[46:47]
    v_pk_fma_f32 v[56:57], v[56:57], v[60:61], v[60:61]
    v_pk_fma_f32 v[58:59], v[58:59], v[62:63], v[62:63]
    v_pk_mul_f32 v[40:41], v[40:41], v[48:49]
    v_pk_mul_f32 v[42:43], v[42:43], v[50:51]
    v_pk_fma_f32 v[32:33], v[32:33], v[56:57], v[40:41]
    s_cmp_le_i32 s63, 11
    v_pk_fma_f32 v[34:35], v[34:35], v[58:59], v[42:43]
    v_pk_mul_f32 v[48:49], v[48:49], v[56:57]
    v_pk_mul_f32 v[50:51], v[50:51], v[58:59]
    s_cbranch_scc1 M_evf11
M_evrf11:
    v_rcp_f32 v48, v48
    v_rcp_f32 v49, v49
    v_rcp_f32 v50, v50
    v_rcp_f32 v51, v51
    v_pk_mul_f32 v[32:33], v[32:33], v[48:49]
    v_pk_mul_f32 v[34:35], v[34:35], v[50:51]
    v_cvt_pk_bf16_f32 v66, v32, v33
    v_cvt_pk_bf16_f32 v67, v34, v35
    s_waitcnt vmcnt(7) lgkmcnt(0)
    v_mfma_f32_32x32x16_bf16 v[32:47], v[124:127], v[132:135], 0
    v_exp_f32 v48, v16
    v_exp_f32 v49, v17
    v_exp_f32 v50, v18
    v_exp_f32 v51, v19
    v_mfma_f32_32x32x16_bf16 v[32:47], v[116:119], v[136:139], v[32:47]
    v_exp_f32 v52, v20
    v_exp_f32 v53, v21
    v_exp_f32 v54, v22
    v_exp_f32 v55, v23
    v_mfma_f32_32x32x16_bf16 v[32:47], v[120:123], v[140:143], v[32:47]
    v_exp_f32 v56, v24
    v_exp_f32 v57, v25
    v_exp_f32 v58, v26
    v_exp_f32 v59, v27
    v_exp_f32 v60, v28
    ds_read_b128 v[124:127], v236 offset:7168
    ds_read_b64_tr_b16 v[132:133], v151
    ds_read_b64_tr_b16 v[134:135], v151 offset:2368
    ds_read_b128 v[116:119], v239 offset:4096
    ds_read_b128 v[120:123], v240 offset:4096
    v_exp_f32 v61, v29
    v_exp_f32 v62, v30
    v_exp_f32 v63, v31
    v_pk_fma_f32 v[20:21], v[20:21], v[48:49], v[20:21]
    v_pk_fma_f32 v[22:23], v[22:23], v[50:51], v[22:23]
    v_pk_add_f32 v[52:53], v[52:53], v[228:229]
    v_pk_add_f32 v[54:55], v[54:55], v[228:229]
    v_pk_fma_f32 v[28:29], v[28:29], v[56:57], v[28:29]
    v_pk_fma_f32 v[30:31], v[30:31], v[58:59], v[30:31]
    v_pk_add_f32 v[60:61], v[60:61], v[228:229]
    buffer_load_dwordx4 v210, s[48:51], 0 offen offset:2048  lds
    buffer_load_dwordx4 v211, s[48:51], 0 offen offset:3072  lds
    buffer_load_dwordx4 v[192:195], v249, s[44:47], s27 offen offset:0 sc1
    v_pk_add_f32 v[62:63], v[62:63], v[228:229]
    v_pk_fma_f32 v[16:17], v[16:17], v[52:53], v[20:21]
    v_pk_fma_f32 v[18:19], v[18:19], v[54:55], v[22:23]
    v_pk_fma_f32 v[48:49], v[48:49], v[52:53], v[52:53]
    v_pk_fma_f32 v[50:51], v[50:51], v[54:55], v[54:55]
    v_pk_fma_f32 v[24:25], v[24:25], v[60:61], v[28:29]
    v_pk_fma_f32 v[26:27], v[26:27], v[62:63], v[30:31]
    v_pk_fma_f32 v[56:57], v[56:57], v[60:61], v[60:61]
    v_pk_fma_f32 v[58:59], v[58:59], v[62:63], v[62:63]
    v_pk_mul_f32 v[24:25], v[24:25], v[48:49]
    v_pk_mul_f32 v[26:27], v[26:27], v[50:51]
    v_pk_fma_f32 v[16:17], v[16:17], v[56:57], v[24:25]
    s_cmp_le_i32 s63, 12
    v_pk_fma_f32 v[18:19], v[18:19], v[58:59], v[26:27]
    v_pk_mul_f32 v[48:49], v[48:49], v[56:57]
    v_pk_mul_f32 v[50:51], v[50:51], v[58:59]
    s_cbranch_scc1 M_evf12
M_evrf12:
    v_mfma_f32_32x32x16_bf16 v[68:83], v[64:67], v[128:131], v[68:83]
    v_rcp_f32 v48, v48
    v_rcp_f32 v49, v49
    v_rcp_f32 v50, v50
    v_rcp_f32 v51, v51
    v_pk_mul_f32 v[16:17], v[16:17], v[48:49]
    v_pk_mul_f32 v[18:19], v[18:19], v[50:51]
    v_cvt_pk_bf16_f32 v64, v16, v17
    v_cvt_pk_bf16_f32 v65, v18, v19
    s_waitcnt vmcnt(7) lgkmcnt(0)
    v_mfma_f32_32x32x16_bf16 v[16:31], v[124:127], v[132:135], 0
    v_exp_f32 v48, v32
    v_exp_f32 v49, v33
    v_exp_f32 v50, v34
    v_exp_f32 v51, v35
    v_mfma_f32_32x32x16_bf16 v[16:31], v[116:119], v[136:139], v[16:31]
    v_exp_f32 v52, v36
    v_exp_f32 v53, v37
    v_exp_f32 v54, v38
    v_exp_f32 v55, v39
    v_mfma_f32_32x32x16_bf16 v[16:31], v[120:123], v[140:143], v[16:31]
    v_exp_f32 v56, v40
    v_exp_f32 v57, v41
    v_exp_f32 v58, v42
    v_exp_f32 v59, v43
    v_exp_f32 v60, v44
    s_mov_b32 m0, s70
    ds_read_b128 v[124:127], v236 offset:7680
    ds_read2st64_b64 v[128:131], v237 offset0:12 offset1:13
    ds_read_b128 v[116:119], v239 offset:6144
    ds_read_b128 v[120:123], v240 offset:6144
    v_exp_f32 v61, v45
    v_exp_f32 v62, v46
    v_exp_f32 v63, v47
    v_pk_fma_f32 v[36:37], v[36:37], v[48:49], v[36:37]
    v_pk_fma_f32 v[38:39], v[38:39], v[50:51], v[38:39]
    v_pk_add_f32 v[52:53], v[52:53], v[228:229]
    v_pk_add_f32 v[54:55], v[54:55], v[228:229]
    v_pk_fma_f32 v[44:45], v[44:45], v[56:57], v[44:45]
    v_pk_fma_f32 v[46:47], v[46:47], v[58:59], v[46:47]
    v_pk_add_f32 v[60:61], v[60:61], v[228:229]
    buffer_load_dwordx4 v212, s[48:51], 0 offen offset:0  lds
    buffer_load_dwordx4 v213, s[48:51], 0 offen offset:1024  lds
    buffer_load_dwordx4 v[196:199], v249, s[44:47], s27 offen offset:1024 sc1
    v_pk_add_f32 v[62:63], v[62:63], v[228:229]
    v_pk_fma_f32 v[32:33], v[32:33], v[52:53], v[36:37]
    v_pk_fma_f32 v[34:35], v[34:35], v[54:55], v[38:39]
    v_pk_fma_f32 v[48:49], v[48:49], v[52:53], v[52:53]
    v_pk_fma_f32 v[50:51], v[50:51], v[54:55], v[54:55]
    v_pk_fma_f32 v[40:41], v[40:41], v[60:61], v[44:45]
    v_pk_fma_f32 v[42:43], v[42:43], v[62:63], v[46:47]
    v_pk_fma_f32 v[56:57], v[56:57], v[60:61], v[60:61]
    v_pk_fma_f32 v[58:59], v[58:59], v[62:63], v[62:63]
    v_pk_mul_f32 v[40:41], v[40:41], v[48:49]
    v_pk_mul_f32 v[42:43], v[42:43], v[50:51]
    v_pk_fma_f32 v[32:33], v[32:33], v[56:57], v[40:41]
    s_cmp_le_i32 s63, 13
    v_pk_fma_f32 v[34:35], v[34:35], v[58:59], v[42:43]
    v_pk_mul_f32 v[48:49], v[48:49], v[56:57]
    v_pk_mul_f32 v[50:51], v[50:51], v[58:59]
    s_cbranch_scc1 M_evf13
M_evrf13:
    v_rcp_f32 v48, v48
    v_rcp_f32 v49, v49
    v_rcp_f32 v50, v50
    v_rcp_f32 v51, v51
    v_pk_mul_f32 v[32:33], v[32:33], v[48:49]
    v_pk_mul_f32 v[34:35], v[34:35], v[50:51]
    v_cvt_pk_bf16_f32 v66, v32, v33
    v_cvt_pk_bf16_f32 v67, v34, v35
    s_waitcnt vmcnt(7) lgkmcnt(0)
    v_mfma_f32_32x32x16_bf16 v[32:47], v[124:127], v[132:135], 0
    v_exp_f32 v48, v16
    v_exp_f32 v49, v17
    v_exp_f32 v50, v18
    v_exp_f32 v51, v19
    v_mfma_f32_32x32x16_bf16 v[32:47], v[116:119], v[136:139], v[32:47]
    v_exp_f32 v52, v20
    v_exp_f32 v53, v21
    v_exp_f32 v54, v22
    v_exp_f32 v55, v23
    v_mfma_f32_32x32x16_bf16 v[32:47], v[120:123], v[140:143], v[32:47]
    v_exp_f32 v56, v24
    v_exp_f32 v57, v25
    v_exp_f32 v58, v26
    v_exp_f32 v59, v27
    v_exp_f32 v60, v28
    ds_read_b128 v[124:127], v236 offset:8192
    ds_read_b64_tr_b16 v[132:133], v152
    ds_read_b64_tr_b16 v[134:135], v152 offset:2368
    ds_read_b128 v[116:119], v239 offset:0
    ds_read_b128 v[120:123], v240 offset:0
    v_exp_f32 v61, v29
    v_exp_f32 v62, v30
    v_exp_f32 v63, v31
    v_pk_fma_f32 v[20:21], v[20:21], v[48:49], v[20:21]
    v_pk_fma_f32 v[22:23], v[22:23], v[50:51], v[22:23]
    v_pk_add_f32 v[52:53], v[52:53], v[228:229]
    v_pk_add_f32 v[54:55], v[54:55], v[228:229]
    v_pk_fma_f32 v[28:29], v[28:29], v[56:57], v[28:29]
    v_pk_fma_f32 v[30:31], v[30:31], v[58:59], v[30:31]
    v_pk_add_f32 v[60:61], v[60:61], v[228:229]
    buffer_load_dwordx4 v214, s[48:51], 0 offen offset:2048  lds
    buffer_load_dwordx4 v215, s[48:51], 0 offen offset:3072  lds
    buffer_load_dwordx4 v[200:203], v249, s[44:47], s27 offen offset:2048 sc1
    v_pk_add_f32 v[62:63], v[62:63], v[228:229]
    v_pk_fma_f32 v[16:17], v[16:17], v[52:53], v[20:21]
    v_pk_fma_f32 v[18:19], v[18:19], v[54:55], v[22:23]
    v_pk_fma_f32 v[48:49], v[48:49], v[52:53], v[52:53]
    v_pk_fma_f32 v[50:51], v[50:51], v[54:55], v[54:55]
    v_pk_fma_f32 v[24:25], v[24:25], v[60:61], v[28:29]
    v_pk_fma_f32 v[26:27], v[26:27], v[62:63], v[30:31]
    v_pk_fma_f32 v[56:57], v[56:57], v[60:61], v[60:61]
    v_pk_fma_f32 v[58:59], v[58:59], v[62:63], v[62:63]
    v_pk_mul_f32 v[24:25], v[24:25], v[48:49]
    v_pk_mul_f32 v[26:27], v[26:27], v[50:51]
    v_pk_fma_f32 v[16:17], v[16:17], v[56:57], v[24:25]
    s_cmp_le_i32 s63, 14
    v_pk_fma_f32 v[18:19], v[18:19], v[58:59], v[26:27]
    v_pk_mul_f32 v[48:49], v[48:49], v[56:57]
    v_pk_mul_f32 v[50:51], v[50:51], v[58:59]
    s_cbranch_scc1 M_evf14
M_evrf14:
    v_mfma_f32_32x32x16_bf16 v[68:83], v[64:67], v[128:131], v[68:83]
    v_rcp_f32 v48, v48
    v_rcp_f32 v49, v49
    v_rcp_f32 v50, v50
    v_rcp_f32 v51, v51
    v_pk_mul_f32 v[16:17], v[16:17], v[48:49]
    v_pk_mul_f32 v[18:19], v[18:19], v[50:51]
    v_cvt_pk_bf16_f32 v64, v16, v17
    v_cvt_pk_bf16_f32 v65, v18, v19
    s_waitcnt vmcnt(7) lgkmcnt(0)
    v_mfma_f32_32x32x16_bf16 v[16:31], v[124:127], v[132:135], 0
    v_exp_f32 v48, v32
    v_exp_f32 v49, v33
    v_exp_f32 v50, v34
    v_exp_f32 v51, v35
    v_mfma_f32_32x32x16_bf16 v[16:31], v[116:119], v[136:139], v[16:31]
    v_exp_f32 v52, v36
    v_exp_f32 v53, v37
    v_exp_f32 v54, v38
    v_exp_f32 v55, v39
    v_mfma_f32_32x32x16_bf16 v[16:31], v[120:123], v[140:143], v[16:31]
    v_exp_f32 v56, v40
    v_exp_f32 v57, v41
    v_exp_f32 v58, v42
    v_exp_f32 v59, v43
    v_exp_f32 v60, v44
    s_mov_b32 m0, s66
    ds_read_b128 v[124:127], v236 offset:8704
    ds_read2st64_b64 v[128:131], v237 offset0:14 offset1:15
    ds_read_b128 v[116:119], v239 offset:2048
    ds_read_b128 v[120:123], v240 offset:2048
    v_exp_f32 v61, v45
    v_exp_f32 v62, v46
    v_exp_f32 v63, v47
    v_pk_fma_f32 v[36:37], v[36:37], v[48:49], v[36:37]
    v_pk_fma_f32 v[38:39], v[38:39], v[50:51], v[38:39]
    v_pk_add_f32 v[52:53], v[52:53], v[228:229]
    v_pk_add_f32 v[54:55], v[54:55], v[228:229]
    v_pk_fma_f32 v[44:45], v[44:45], v[56:57], v[44:45]
    v_pk_fma_f32 v[46:47], v[46:47], v[58:59], v[46:47]
    v_pk_add_f32 v[60:61], v[60:61], v[228:229]
    buffer_load_dwordx4 v216, s[48:51], 0 offen offset:0  lds
    buffer_load_dwordx4 v217, s[48:51], 0 offen offset:1024  lds
    buffer_load_dwordx4 v[204:207], v249, s[44:47], s27 offen offset:3072 sc1
    v_pk_add_f32 v[62:63], v[62:63], v[228:229]
    v_pk_fma_f32 v[32:33], v[32:33], v[52:53], v[36:37]
    v_pk_fma_f32 v[34:35], v[34:35], v[54:55], v[38:39]
    v_pk_fma_f32 v[48:49], v[48:49], v[52:53], v[52:53]
    v_pk_fma_f32 v[50:51], v[50:51], v[54:55], v[54:55]
    v_pk_fma_f32 v[40:41], v[40:41], v[60:61], v[44:45]
    v_pk_fma_f32 v[42:43], v[42:43], v[62:63], v[46:47]
    v_pk_fma_f32 v[56:57], v[56:57], v[60:61], v[60:61]
    v_pk_fma_f32 v[58:59], v[58:59], v[62:63], v[62:63]
    v_pk_mul_f32 v[40:41], v[40:41], v[48:49]
    v_pk_mul_f32 v[42:43], v[42:43], v[50:51]
    v_pk_fma_f32 v[32:33], v[32:33], v[56:57], v[40:41]
    s_cmp_le_i32 s63, 15
    v_pk_fma_f32 v[34:35], v[34:35], v[58:59], v[42:43]
    v_pk_mul_f32 v[48:49], v[48:49], v[56:57]
    v_pk_mul_f32 v[50:51], v[50:51], v[58:59]
    s_cbranch_scc1 M_evf15
M_evrf15:
    v_rcp_f32 v48, v48
    v_rcp_f32 v49, v49
    v_rcp_f32 v50, v50
    v_rcp_f32 v51, v51
    v_pk_mul_f32 v[32:33], v[32:33], v[48:49]
    v_pk_mul_f32 v[34:35], v[34:35], v[50:51]
    v_cvt_pk_bf16_f32 v66, v32, v33
    v_cvt_pk_bf16_f32 v67, v34, v35
    s_waitcnt vmcnt(7) lgkmcnt(0)
    v_mfma_f32_32x32x16_bf16 v[32:47], v[124:127], v[132:135], 0
    v_exp_f32 v48, v16
    v_exp_f32 v49, v17
    v_exp_f32 v50, v18
    v_exp_f32 v51, v19
    v_mfma_f32_32x32x16_bf16 v[32:47], v[116:119], v[136:139], v[32:47]
    v_exp_f32 v52, v20
    v_exp_f32 v53, v21
    v_exp_f32 v54, v22
    v_exp_f32 v55, v23
    v_mfma_f32_32x32x16_bf16 v[32:47], v[120:123], v[140:143], v[32:47]
    v_exp_f32 v56, v24
    v_exp_f32 v57, v25
    v_exp_f32 v58, v26
    v_exp_f32 v59, v27
    v_exp_f32 v60, v28
    ds_read_b128 v[124:127], v236 offset:9216
    ds_read_b64_tr_b16 v[132:133], v153
    ds_read_b64_tr_b16 v[134:135], v153 offset:2368
    ds_read_b128 v[116:119], v239 offset:4096
    ds_read_b128 v[120:123], v240 offset:4096
    v_exp_f32 v61, v29
    v_exp_f32 v62, v30
    v_exp_f32 v63, v31
    v_pk_fma_f32 v[20:21], v[20:21], v[48:49], v[20:21]
    v_pk_fma_f32 v[22:23], v[22:23], v[50:51], v[22:23]
    v_pk_add_f32 v[52:53], v[52:53], v[228:229]
    v_pk_add_f32 v[54:55], v[54:55], v[228:229]
    v_pk_fma_f32 v[28:29], v[28:29], v[56:57], v[28:29]
    v_pk_fma_f32 v[30:31], v[30:31], v[58:59], v[30:31]
    v_pk_add_f32 v[60:61], v[60:61], v[228:229]
    buffer_load_dwordx4 v218, s[48:51], 0 offen offset:2048  lds
    buffer_load_dwordx4 v219, s[48:51], 0 offen offset:3072  lds
    v_pk_add_f32 v[62:63], v[62:63], v[228:229]
    v_pk_fma_f32 v[16:17], v[16:17], v[52:53], v[20:21]
    v_pk_fma_f32 v[18:19], v[18:19], v[54:55], v[22:23]
    v_pk_fma_f32 v[48:49], v[48:49], v[52:53], v[52:53]
    v_pk_fma_f32 v[50:51], v[50:51], v[54:55], v[54:55]
    v_pk_fma_f32 v[24:25], v[24:25], v[60:61], v[28:29]
    v_pk_fma_f32 v[26:27], v[26:27], v[62:63], v[30:31]
    v_pk_fma_f32 v[56:57], v[56:57], v[60:61], v[60:61]
    v_pk_fma_f32 v[58:59], v[58:59], v[62:63], v[62:63]
    v_pk_mul_f32 v[24:25], v[24:25], v[48:49]
    v_pk_mul_f32 v[26:27], v[26:27], v[50:51]
    v_pk_fma_f32 v[16:17], v[16:17], v[56:57], v[24:25]
    s_cmp_le_i32 s63, 16
    v_pk_fma_f32 v[18:19], v[18:19], v[58:59], v[26:27]
    v_pk_mul_f32 v[48:49], v[48:49], v[56:57]
    v_pk_mul_f32 v[50:51], v[50:51], v[58:59]
    s_cbranch_scc1 M_evf16
M_evrf16:
    v_mfma_f32_32x32x16_bf16 v[68:83], v[64:67], v[128:131], v[68:83]
    v_rcp_f32 v48, v48
    v_rcp_f32 v49, v49
    v_rcp_f32 v50, v50
    v_rcp_f32 v51, v51
    v_pk_mul_f32 v[16:17], v[16:17], v[48:49]
    v_pk_mul_f32 v[18:19], v[18:19], v[50:51]
    v_cvt_pk_bf16_f32 v64, v16, v17
    v_cvt_pk_bf16_f32 v65, v18, v19
    s_waitcnt vmcnt(6) lgkmcnt(0)
    v_mfma_f32_32x32x16_bf16 v[16:31], v[124:127], v[132:135], 0
    v_exp_f32 v48, v32
    v_exp_f32 v49, v33
    v_exp_f32 v50, v34
    v_exp_f32 v51, v35
    v_mfma_f32_32x32x16_bf16 v[16:31], v[116:119], v[136:139], v[16:31]
    v_exp_f32 v52, v36
    v_exp_f32 v53, v37
    v_exp_f32 v54, v38
    v_exp_f32 v55, v39
    v_mfma_f32_32x32x16_bf16 v[16:31], v[120:123], v[140:143], v[16:31]
    v_exp_f32 v56, v40
    v_exp_f32 v57, v41
    v_exp_f32 v58, v42
    v_exp_f32 v59, v43
    v_exp_f32 v60, v44
    s_mov_b32 m0, s70
    ds_read_b128 v[124:127], v236 offset:9728
    ds_read2st64_b64 v[128:131], v237 offset0:16 offset1:17
    ds_read_b128 v[116:119], v239 offset:6144
    ds_read_b128 v[120:123], v240 offset:6144
    v_exp_f32 v61, v45
    v_exp_f32 v62, v46
    v_exp_f32 v63, v47
    v_pk_fma_f32 v[36:37], v[36:37], v[48:49], v[36:37]
    v_pk_fma_f32 v[38:39], v[38:39], v[50:51], v[38:39]
    v_pk_add_f32 v[52:53], v[52:53], v[228:229]
    v_pk_add_f32 v[54:55], v[54:55], v[228:229]
    v_pk_fma_f32 v[44:45], v[44:45], v[56:57], v[44:45]
    v_pk_fma_f32 v[46:47], v[46:47], v[58:59], v[46:47]
    v_pk_add_f32 v[60:61], v[60:61], v[228:229]
    buffer_load_dwordx4 v220, s[48:51], 0 offen offset:0  lds
    buffer_load_dwordx4 v221, s[48:51], 0 offen offset:1024  lds
    v_pk_add_f32 v[62:63], v[62:63], v[228:229]
    v_pk_fma_f32 v[32:33], v[32:33], v[52:53], v[36:37]
    v_pk_fma_f32 v[34:35], v[34:35], v[54:55], v[38:39]
    v_pk_fma_f32 v[48:49], v[48:49], v[52:53], v[52:53]
    v_pk_fma_f32 v[50:51], v[50:51], v[54:55], v[54:55]
    v_pk_fma_f32 v[40:41], v[40:41], v[60:61], v[44:45]
    v_pk_fma_f32 v[42:43], v[42:43], v[62:63], v[46:47]
    v_pk_fma_f32 v[56:57], v[56:57], v[60:61], v[60:61]
    v_pk_fma_f32 v[58:59], v[58:59], v[62:63], v[62:63]
    v_pk_mul_f32 v[40:41], v[40:41], v[48:49]
    v_pk_mul_f32 v[42:43], v[42:43], v[50:51]
    v_pk_fma_f32 v[32:33], v[32:33], v[56:57], v[40:41]
    s_cmp_le_i32 s63, 17
    v_pk_fma_f32 v[34:35], v[34:35], v[58:59], v[42:43]
    v_pk_mul_f32 v[48:49], v[48:49], v[56:57]
    v_pk_mul_f32 v[50:51], v[50:51], v[58:59]
    s_cbranch_scc1 M_evf17
M_evrf17:
    v_rcp_f32 v48, v48
    v_rcp_f32 v49, v49
    v_rcp_f32 v50, v50
    v_rcp_f32 v51, v51
    v_pk_mul_f32 v[32:33], v[32:33], v[48:49]
    v_pk_mul_f32 v[34:35], v[34:35], v[50:51]
    v_cvt_pk_bf16_f32 v66, v32, v33
    v_cvt_pk_bf16_f32 v67, v34, v35
    s_waitcnt vmcnt(5) lgkmcnt(0)
    v_mfma_f32_32x32x16_bf16 v[32:47], v[124:127], v[132:135], 0
    v_exp_f32 v48, v16
    v_exp_f32 v49, v17
    v_exp_f32 v50, v18
    v_exp_f32 v51, v19
    v_mfma_f32_32x32x16_bf16 v[32:47], v[116:119], v[136:139], v[32:47]
    v_exp_f32 v52, v20
    v_exp_f32 v53, v21
    v_exp_f32 v54, v22
    v_exp_f32 v55, v23
    v_mfma_f32_32x32x16_bf16 v[32:47], v[120:123], v[140:143], v[32:47]
    v_exp_f32 v56, v24
    v_exp_f32 v57, v25
    v_exp_f32 v58, v26
    v_exp_f32 v59, v27
    v_exp_f32 v60, v28
    ds_read_b128 v[124:127], v236 offset:10240
    ds_read_b64_tr_b16 v[132:133], v154
    ds_read_b64_tr_b16 v[134:135], v154 offset:2368
    ds_read_b128 v[116:119], v239 offset:0
    ds_read_b128 v[120:123], v240 offset:0
    v_exp_f32 v61, v29
    v_exp_f32 v62, v30
    v_exp_f32 v63, v31
    v_pk_fma_f32 v[20:21], v[20:21], v[48:49], v[20:21]
    v_pk_fma_f32 v[22:23], v[22:23], v[50:51], v[22:23]
    v_pk_add_f32 v[52:53], v[52:53], v[228:229]
    v_pk_add_f32 v[54:55], v[54:55], v[228:229]
    v_pk_fma_f32 v[28:29], v[28:29], v[56:57], v[28:29]
    v_pk_fma_f32 v[30:31], v[30:31], v[58:59], v[30:31]
    v_pk_add_f32 v[60:61], v[60:61], v[228:229]
    buffer_load_dwordx4 v222, s[48:51], 0 offen offset:2048  lds
    buffer_load_dwordx4 v223, s[48:51], 0 offen offset:3072  lds
    v_pk_add_f32 v[62:63], v[62:63], v[228:229]
    v_pk_fma_f32 v[16:17], v[16:17], v[52:53], v[20:21]
    v_pk_fma_f32 v[18:19], v[18:19], v[54:55], v[22:23]
    v_pk_fma_f32 v[48:49], v[48:49], v[52:53], v[52:53]
    v_pk_fma_f32 v[50:51], v[50:51], v[54:55], v[54:55]
    v_pk_fma_f32 v[24:25], v[24:25], v[60:61], v[28:29]
    v_pk_fma_f32 v[26:27], v[26:27], v[62:63], v[30:31]
    v_pk_fma_f32 v[56:57], v[56:57], v[60:61], v[60:61]
    v_pk_fma_f32 v[58:59], v[58:59], v[62:63], v[62:63]
    v_pk_mul_f32 v[24:25], v[24:25], v[48:49]
    v_pk_mul_f32 v[26:27], v[26:27], v[50:51]
    v_pk_fma_f32 v[16:17], v[16:17], v[56:57], v[24:25]
    s_cmp_le_i32 s63, 18
    v_pk_fma_f32 v[18:19], v[18:19], v[58:59], v[26:27]
    v_pk_mul_f32 v[48:49], v[48:49], v[56:57]
    v_pk_mul_f32 v[50:51], v[50:51], v[58:59]
    s_cbranch_scc1 M_evf18
M_evrf18:
    v_mfma_f32_32x32x16_bf16 v[68:83], v[64:67], v[128:131], v[68:83]
    v_rcp_f32 v48, v48
    v_rcp_f32 v49, v49
    v_rcp_f32 v50, v50
    v_rcp_f32 v51, v51
    v_pk_mul_f32 v[16:17], v[16:17], v[48:49]
    v_pk_mul_f32 v[18:19], v[18:19], v[50:51]
    v_cvt_pk_bf16_f32 v64, v16, v17
    v_cvt_pk_bf16_f32 v65, v18, v19
    s_waitcnt vmcnt(4) lgkmcnt(0)
    v_mfma_f32_32x32x16_bf16 v[16:31], v[124:127], v[132:135], 0
    v_exp_f32 v48, v32
    v_exp_f32 v49, v33
    v_exp_f32 v50, v34
    v_exp_f32 v51, v35
    v_mfma_f32_32x32x16_bf16 v[16:31], v[116:119], v[136:139], v[16:31]
    v_exp_f32 v52, v36
    v_exp_f32 v53, v37
    v_exp_f32 v54, v38
    v_exp_f32 v55, v39
    v_mfma_f32_32x32x16_bf16 v[16:31], v[120:123], v[140:143], v[16:31]
    v_exp_f32 v56, v40
    v_exp_f32 v57, v41
    v_exp_f32 v58, v42
    v_exp_f32 v59, v43
    v_exp_f32 v60, v44
    s_mov_b32 m0, s66
    ds_read_b128 v[124:127], v236 offset:10752
    ds_read2st64_b64 v[128:131], v237 offset0:18 offset1:19
    ds_read_b128 v[116:119], v239 offset:2048
    ds_read_b128 v[120:123], v240 offset:2048
    v_exp_f32 v61, v45
    v_exp_f32 v62, v46
    v_exp_f32 v63, v47
    v_pk_fma_f32 v[36:37], v[36:37], v[48:49], v[36:37]
    v_pk_fma_f32 v[38:39], v[38:39], v[50:51], v[38:39]
    v_pk_add_f32 v[52:53], v[52:53], v[228:229]
    v_pk_add_f32 v[54:55], v[54:55], v[228:229]
    v_pk_fma_f32 v[44:45], v[44:45], v[56:57], v[44:45]
    v_pk_fma_f32 v[46:47], v[46:47], v[58:59], v[46:47]
    v_pk_add_f32 v[60:61], v[60:61], v[228:229]
    buffer_load_dwordx4 v224, s[48:51], 0 offen offset:0  lds
    buffer_load_dwordx4 v225, s[48:51], 0 offen offset:1024  lds
    v_pk_add_f32 v[62:63], v[62:63], v[228:229]
    v_pk_fma_f32 v[32:33], v[32:33], v[52:53], v[36:37]
    v_pk_fma_f32 v[34:35], v[34:35], v[54:55], v[38:39]
    v_pk_fma_f32 v[48:49], v[48:49], v[52:53], v[52:53]
    v_pk_fma_f32 v[50:51], v[50:51], v[54:55], v[54:55]
    v_pk_fma_f32 v[40:41], v[40:41], v[60:61], v[44:45]
    v_pk_fma_f32 v[42:43], v[42:43], v[62:63], v[46:47]
    v_pk_fma_f32 v[56:57], v[56:57], v[60:61], v[60:61]
    v_pk_fma_f32 v[58:59], v[58:59], v[62:63], v[62:63]
    v_pk_mul_f32 v[40:41], v[40:41], v[48:49]
    v_pk_mul_f32 v[42:43], v[42:43], v[50:51]
    v_pk_fma_f32 v[32:33], v[32:33], v[56:57], v[40:41]
    s_cmp_le_i32 s63, 19
    v_pk_fma_f32 v[34:35], v[34:35], v[58:59], v[42:43]
    v_pk_mul_f32 v[48:49], v[48:49], v[56:57]
    v_pk_mul_f32 v[50:51], v[50:51], v[58:59]
    s_cbranch_scc1 M_evf19
M_evrf19:
    v_rcp_f32 v48, v48
    v_rcp_f32 v49, v49
    v_rcp_f32 v50, v50
    v_rcp_f32 v51, v51
    v_pk_mul_f32 v[32:33], v[32:33], v[48:49]
    v_pk_mul_f32 v[34:35], v[34:35], v[50:51]
    v_cvt_pk_bf16_f32 v66, v32, v33
    v_cvt_pk_bf16_f32 v67, v34, v35
    s_waitcnt vmcnt(4) lgkmcnt(0)
    v_mfma_f32_32x32x16_bf16 v[32:47], v[124:127], v[132:135], 0
    v_exp_f32 v48, v16
    v_exp_f32 v49, v17
    v_exp_f32 v50, v18
    v_exp_f32 v51, v19
    v_mfma_f32_32x32x16_bf16 v[32:47], v[116:119], v[136:139], v[32:47]
    v_exp_f32 v52, v20
    v_exp_f32 v53, v21
    v_exp_f32 v54, v22
    v_exp_f32 v55, v23
    v_mfma_f32_32x32x16_bf16 v[32:47], v[120:123], v[140:143], v[32:47]
    v_exp_f32 v56, v24
    v_exp_f32 v57, v25
    v_exp_f32 v58, v26
    v_exp_f32 v59, v27
    v_exp_f32 v60, v28
    ds_read_b128 v[124:127], v236 offset:11264
    ds_read_b64_tr_b16 v[132:133], v155
    ds_read_b64_tr_b16 v[134:135], v155 offset:2368
    ds_read_b128 v[116:119], v239 offset:4096
    ds_read_b128 v[120:123], v240 offset:4096
    v_exp_f32 v61, v29
    v_exp_f32 v62, v30
    v_exp_f32 v63, v31
    v_pk_fma_f32 v[20:21], v[20:21], v[48:49], v[20:21]
    v_pk_fma_f32 v[22:23], v[22:23], v[50:51], v[22:23]
    v_pk_add_f32 v[52:53], v[52:53], v[228:229]
    v_pk_add_f32 v[54:55], v[54:55], v[228:229]
    v_pk_fma_f32 v[28:29], v[28:29], v[56:57], v[28:29]
    v_pk_fma_f32 v[30:31], v[30:31], v[58:59], v[30:31]
    v_pk_add_f32 v[60:61], v[60:61], v[228:229]
    buffer_load_dwordx4 v226, s[48:51], 0 offen offset:2048  lds
    buffer_load_dwordx4 v227, s[48:51], 0 offen offset:3072  lds
    v_pk_add_f32 v[62:63], v[62:63], v[228:229]
    v_pk_fma_f32 v[16:17], v[16:17], v[52:53], v[20:21]
    v_pk_fma_f32 v[18:19], v[18:19], v[54:55], v[22:23]
    v_pk_fma_f32 v[48:49], v[48:49], v[52:53], v[52:53]
    v_pk_fma_f32 v[50:51], v[50:51], v[54:55], v[54:55]
    v_pk_fma_f32 v[24:25], v[24:25], v[60:61], v[28:29]
    v_pk_fma_f32 v[26:27], v[26:27], v[62:63], v[30:31]
    v_pk_fma_f32 v[56:57], v[56:57], v[60:61], v[60:61]
    v_pk_fma_f32 v[58:59], v[58:59], v[62:63], v[62:63]
    v_pk_mul_f32 v[24:25], v[24:25], v[48:49]
    v_pk_mul_f32 v[26:27], v[26:27], v[50:51]
    v_pk_fma_f32 v[16:17], v[16:17], v[56:57], v[24:25]
    s_cmp_le_i32 s63, 20
    v_pk_fma_f32 v[18:19], v[18:19], v[58:59], v[26:27]
    v_pk_mul_f32 v[48:49], v[48:49], v[56:57]
    v_pk_mul_f32 v[50:51], v[50:51], v[58:59]
    s_cbranch_scc1 M_evf20
M_evrf20:
    v_mfma_f32_32x32x16_bf16 v[68:83], v[64:67], v[128:131], v[68:83]
    v_rcp_f32 v48, v48
    v_rcp_f32 v49, v49
    v_rcp_f32 v50, v50
    v_rcp_f32 v51, v51
    v_pk_mul_f32 v[16:17], v[16:17], v[48:49]
    v_pk_mul_f32 v[18:19], v[18:19], v[50:51]
    v_cvt_pk_bf16_f32 v64, v16, v17
    v_cvt_pk_bf16_f32 v65, v18, v19
    s_waitcnt vmcnt(4) lgkmcnt(0)
    v_mfma_f32_32x32x16_bf16 v[16:31], v[124:127], v[132:135], 0
    v_exp_f32 v48, v32
    v_exp_f32 v49, v33
    v_exp_f32 v50, v34
    v_exp_f32 v51, v35
    v_mfma_f32_32x32x16_bf16 v[16:31], v[116:119], v[136:139], v[16:31]
    v_exp_f32 v52, v36
    v_exp_f32 v53, v37
    v_exp_f32 v54, v38
    v_exp_f32 v55, v39
    v_mfma_f32_32x32x16_bf16 v[16:31], v[120:123], v[140:143], v[16:31]
    v_exp_f32 v56, v40
    v_exp_f32 v57, v41
    v_exp_f32 v58, v42
    v_exp_f32 v59, v43
    v_exp_f32 v60, v44
    s_mov_b32 m0, s70
    ds_read_b128 v[124:127], v236 offset:11776
    ds_read2st64_b64 v[128:131], v237 offset0:20 offset1:21
    ds_read_b128 v[116:119], v239 offset:6144
    ds_read_b128 v[120:123], v240 offset:6144
    v_exp_f32 v61, v45
    v_exp_f32 v62, v46
    v_exp_f32 v63, v47
    v_pk_fma_f32 v[36:37], v[36:37], v[48:49], v[36:37]
    v_pk_fma_f32 v[38:39], v[38:39], v[50:51], v[38:39]
    v_pk_add_f32 v[52:53], v[52:53], v[228:229]
    v_pk_add_f32 v[54:55], v[54:55], v[228:229]
    v_pk_fma_f32 v[44:45], v[44:45], v[56:57], v[44:45]
    v_pk_fma_f32 v[46:47], v[46:47], v[58:59], v[46:47]
    v_pk_add_f32 v[60:61], v[60:61], v[228:229]
    buffer_load_dwordx4 v247, s[48:51], 0 offen offset:0  lds
    buffer_load_dwordx4 v247, s[48:51], 0 offen offset:1024  lds
    v_pk_add_f32 v[62:63], v[62:63], v[228:229]
    v_pk_fma_f32 v[32:33], v[32:33], v[52:53], v[36:37]
    v_pk_fma_f32 v[34:35], v[34:35], v[54:55], v[38:39]
    v_pk_fma_f32 v[48:49], v[48:49], v[52:53], v[52:53]
    v_pk_fma_f32 v[50:51], v[50:51], v[54:55], v[54:55]
    v_pk_fma_f32 v[40:41], v[40:41], v[60:61], v[44:45]
    v_pk_fma_f32 v[42:43], v[42:43], v[62:63], v[46:47]
    v_pk_fma_f32 v[56:57], v[56:57], v[60:61], v[60:61]
    v_pk_fma_f32 v[58:59], v[58:59], v[62:63], v[62:63]
    v_pk_mul_f32 v[40:41], v[40:41], v[48:49]
    v_pk_mul_f32 v[42:43], v[42:43], v[50:51]
    v_pk_fma_f32 v[32:33], v[32:33], v[56:57], v[40:41]
    s_cmp_le_i32 s63, 21
    v_pk_fma_f32 v[34:35], v[34:35], v[58:59], v[42:43]
    v_pk_mul_f32 v[48:49], v[48:49], v[56:57]
    v_pk_mul_f32 v[50:51], v[50:51], v[58:59]
    s_cbranch_scc1 M_evf21
M_evrf21:
    v_rcp_f32 v48, v48
    v_rcp_f32 v49, v49
    v_rcp_f32 v50, v50
    v_rcp_f32 v51, v51
    v_pk_mul_f32 v[32:33], v[32:33], v[48:49]
    v_pk_mul_f32 v[34:35], v[34:35], v[50:51]
    v_cvt_pk_bf16_f32 v66, v32, v33
    v_cvt_pk_bf16_f32 v67, v34, v35
    s_waitcnt vmcnt(4) lgkmcnt(0)
    v_mfma_f32_32x32x16_bf16 v[32:47], v[124:127], v[132:135], 0
    v_exp_f32 v48, v16
    v_exp_f32 v49, v17
    v_exp_f32 v50, v18
    v_exp_f32 v51, v19
    v_mfma_f32_32x32x16_bf16 v[32:47], v[116:119], v[136:139], v[32:47]
    v_exp_f32 v52, v20
    v_exp_f32 v53, v21
    v_exp_f32 v54, v22
    v_exp_f32 v55, v23
    v_mfma_f32_32x32x16_bf16 v[32:47], v[120:123], v[140:143], v[32:47]
    v_exp_f32 v56, v24
    v_exp_f32 v57, v25
    v_exp_f32 v58, v26
    v_exp_f32 v59, v27
    v_exp_f32 v60, v28
    ds_read_b128 v[124:127], v236 offset:12288
    ds_read_b64_tr_b16 v[132:133], v156
    ds_read_b64_tr_b16 v[134:135], v156 offset:2368
    ds_read_b128 v[116:119], v239 offset:0
    ds_read_b128 v[120:123], v240 offset:0
    v_exp_f32 v61, v29
    v_exp_f32 v62, v30
    v_exp_f32 v63, v31
    v_pk_fma_f32 v[20:21], v[20:21], v[48:49], v[20:21]
    v_pk_fma_f32 v[22:23], v[22:23], v[50:51], v[22:23]
    v_pk_add_f32 v[52:53], v[52:53], v[228:229]
    v_pk_add_f32 v[54:55], v[54:55], v[228:229]
    v_pk_fma_f32 v[28:29], v[28:29], v[56:57], v[28:29]
    v_pk_fma_f32 v[30:31], v[30:31], v[58:59], v[30:31]
    v_pk_add_f32 v[60:61], v[60:61], v[228:229]
    buffer_load_dwordx4 v247, s[48:51], 0 offen offset:2048  lds
    buffer_load_dwordx4 v247, s[48:51], 0 offen offset:3072  lds
    v_pk_add_f32 v[62:63], v[62:63], v[228:229]
    v_pk_fma_f32 v[16:17], v[16:17], v[52:53], v[20:21]
    v_pk_fma_f32 v[18:19], v[18:19], v[54:55], v[22:23]
    v_pk_fma_f32 v[48:49], v[48:49], v[52:53], v[52:53]
    v_pk_fma_f32 v[50:51], v[50:51], v[54:55], v[54:55]
    v_pk_fma_f32 v[24:25], v[24:25], v[60:61], v[28:29]
    v_pk_fma_f32 v[26:27], v[26:27], v[62:63], v[30:31]
    v_pk_fma_f32 v[56:57], v[56:57], v[60:61], v[60:61]
    v_pk_fma_f32 v[58:59], v[58:59], v[62:63], v[62:63]
    v_pk_mul_f32 v[24:25], v[24:25], v[48:49]
    v_pk_mul_f32 v[26:27], v[26:27], v[50:51]
    v_pk_fma_f32 v[16:17], v[16:17], v[56:57], v[24:25]
    s_cmp_le_i32 s63, 22
    v_pk_fma_f32 v[18:19], v[18:19], v[58:59], v[26:27]
    v_pk_mul_f32 v[48:49], v[48:49], v[56:57]
    v_pk_mul_f32 v[50:51], v[50:51], v[58:59]
    s_cbranch_scc1 M_evf22
M_evrf22:
    v_mfma_f32_32x32x16_bf16 v[68:83], v[64:67], v[128:131], v[68:83]
    v_rcp_f32 v48, v48
    v_rcp_f32 v49, v49
    v_rcp_f32 v50, v50
    v_rcp_f32 v51, v51
    v_pk_mul_f32 v[16:17], v[16:17], v[48:49]
    v_pk_mul_f32 v[18:19], v[18:19], v[50:51]
    v_cvt_pk_bf16_f32 v64, v16, v17
    v_cvt_pk_bf16_f32 v65, v18, v19
    s_waitcnt vmcnt(4) lgkmcnt(0)
    v_mfma_f32_32x32x16_bf16 v[16:31], v[124:127], v[132:135], 0
    v_exp_f32 v48, v32
    v_exp_f32 v49, v33
    v_exp_f32 v50, v34
    v_exp_f32 v51, v35
    v_mfma_f32_32x32x16_bf16 v[16:31], v[116:119], v[136:139], v[16:31]
    v_exp_f32 v52, v36
    v_exp_f32 v53, v37
    v_exp_f32 v54, v38
    v_exp_f32 v55, v39
    v_mfma_f32_32x32x16_bf16 v[16:31], v[120:123], v[140:143], v[16:31]
    v_exp_f32 v56, v40
    v_exp_f32 v57, v41
    v_exp_f32 v58, v42
    v_exp_f32 v59, v43
    v_exp_f32 v60, v44
    s_mov_b32 m0, s66
    ds_read_b128 v[124:127], v236 offset:12800
    ds_read2st64_b64 v[128:131], v237 offset0:22 offset1:23
    ds_read_b128 v[116:119], v239 offset:2048
    ds_read_b128 v[120:123], v240 offset:2048
    v_exp_f32 v61, v45
    v_exp_f32 v62, v46
    v_exp_f32 v63, v47
    v_pk_fma_f32 v[36:37], v[36:37], v[48:49], v[36:37]
    v_pk_fma_f32 v[38:39], v[38:39], v[50:51], v[38:39]
    v_pk_add_f32 v[52:53], v[52:53], v[228:229]
    v_pk_add_f32 v[54:55], v[54:55], v[228:229]
    v_pk_fma_f32 v[44:45], v[44:45], v[56:57], v[44:45]
    v_pk_fma_f32 v[46:47], v[46:47], v[58:59], v[46:47]
    v_pk_add_f32 v[60:61], v[60:61], v[228:229]
    buffer_load_dwordx4 v247, s[48:51], 0 offen offset:0  lds
    buffer_load_dwordx4 v247, s[48:51], 0 offen offset:1024  lds
    v_pk_add_f32 v[62:63], v[62:63], v[228:229]
    v_pk_fma_f32 v[32:33], v[32:33], v[52:53], v[36:37]
    v_pk_fma_f32 v[34:35], v[34:35], v[54:55], v[38:39]
    v_pk_fma_f32 v[48:49], v[48:49], v[52:53], v[52:53]
    v_pk_fma_f32 v[50:51], v[50:51], v[54:55], v[54:55]
    v_pk_fma_f32 v[40:41], v[40:41], v[60:61], v[44:45]
    v_pk_fma_f32 v[42:43], v[42:43], v[62:63], v[46:47]
    v_pk_fma_f32 v[56:57], v[56:57], v[60:61], v[60:61]
    v_pk_fma_f32 v[58:59], v[58:59], v[62:63], v[62:63]
    v_pk_mul_f32 v[40:41], v[40:41], v[48:49]
    v_pk_mul_f32 v[42:43], v[42:43], v[50:51]
    v_pk_fma_f32 v[32:33], v[32:33], v[56:57], v[40:41]
    s_cmp_le_i32 s63, 23
    v_pk_fma_f32 v[34:35], v[34:35], v[58:59], v[42:43]
    v_pk_mul_f32 v[48:49], v[48:49], v[56:57]
    v_pk_mul_f32 v[50:51], v[50:51], v[58:59]
    s_cbranch_scc1 M_evf23
M_evrf23:
    v_rcp_f32 v48, v48
    v_rcp_f32 v49, v49
    v_rcp_f32 v50, v50
    v_rcp_f32 v51, v51
    v_pk_mul_f32 v[32:33], v[32:33], v[48:49]
    v_pk_mul_f32 v[34:35], v[34:35], v[50:51]
    v_cvt_pk_bf16_f32 v66, v32, v33
    v_cvt_pk_bf16_f32 v67, v34, v35
    s_waitcnt vmcnt(4) lgkmcnt(0)
    v_mfma_f32_32x32x16_bf16 v[32:47], v[124:127], v[132:135], 0
    v_exp_f32 v48, v16
    v_exp_f32 v49, v17
    v_exp_f32 v50, v18
    v_exp_f32 v51, v19
    v_mfma_f32_32x32x16_bf16 v[32:47], v[116:119], v[136:139], v[32:47]
    v_exp_f32 v52, v20
    v_exp_f32 v53, v21
    v_exp_f32 v54, v22
    v_exp_f32 v55, v23
    v_mfma_f32_32x32x16_bf16 v[32:47], v[120:123], v[140:143], v[32:47]
    v_exp_f32 v56, v24
    v_exp_f32 v57, v25
    v_exp_f32 v58, v26
    v_exp_f32 v59, v27
    v_exp_f32 v60, v28
    ds_read_b128 v[124:127], v236 offset:13312
    ds_read_b64_tr_b16 v[132:133], v156
    ds_read_b64_tr_b16 v[134:135], v156 offset:2368
    ds_read_b128 v[116:119], v239 offset:4096
    ds_read_b128 v[120:123], v240 offset:4096
    v_exp_f32 v61, v29
    v_exp_f32 v62, v30
    v_exp_f32 v63, v31
    v_pk_fma_f32 v[20:21], v[20:21], v[48:49], v[20:21]
    v_pk_fma_f32 v[22:23], v[22:23], v[50:51], v[22:23]
    v_pk_add_f32 v[52:53], v[52:53], v[228:229]
    v_pk_add_f32 v[54:55], v[54:55], v[228:229]
    v_pk_fma_f32 v[28:29], v[28:29], v[56:57], v[28:29]
    v_pk_fma_f32 v[30:31], v[30:31], v[58:59], v[30:31]
    v_pk_add_f32 v[60:61], v[60:61], v[228:229]
    buffer_load_dwordx4 v247, s[48:51], 0 offen offset:2048  lds
    buffer_load_dwordx4 v247, s[48:51], 0 offen offset:3072  lds
    v_pk_add_f32 v[62:63], v[62:63], v[228:229]
    v_pk_fma_f32 v[16:17], v[16:17], v[52:53], v[20:21]
    v_pk_fma_f32 v[18:19], v[18:19], v[54:55], v[22:23]
    v_pk_fma_f32 v[48:49], v[48:49], v[52:53], v[52:53]
    v_pk_fma_f32 v[50:51], v[50:51], v[54:55], v[54:55]
    v_pk_fma_f32 v[24:25], v[24:25], v[60:61], v[28:29]
    v_pk_fma_f32 v[26:27], v[26:27], v[62:63], v[30:31]
    v_pk_fma_f32 v[56:57], v[56:57], v[60:61], v[60:61]
    v_pk_fma_f32 v[58:59], v[58:59], v[62:63], v[62:63]
    v_pk_mul_f32 v[24:25], v[24:25], v[48:49]
    v_pk_mul_f32 v[26:27], v[26:27], v[50:51]
    v_pk_fma_f32 v[16:17], v[16:17], v[56:57], v[24:25]
    s_cmp_le_i32 s63, 24
    v_pk_fma_f32 v[18:19], v[18:19], v[58:59], v[26:27]
    v_pk_mul_f32 v[48:49], v[48:49], v[56:57]
    v_pk_mul_f32 v[50:51], v[50:51], v[58:59]
    s_cbranch_scc1 M_evf24
M_evrf24:
    v_mfma_f32_32x32x16_bf16 v[68:83], v[64:67], v[128:131], v[68:83]
    v_rcp_f32 v48, v48
    v_rcp_f32 v49, v49
    v_rcp_f32 v50, v50
    v_rcp_f32 v51, v51
    v_pk_mul_f32 v[16:17], v[16:17], v[48:49]
    v_pk_mul_f32 v[18:19], v[18:19], v[50:51]
    v_cvt_pk_bf16_f32 v64, v16, v17
    v_cvt_pk_bf16_f32 v65, v18, v19
    s_waitcnt vmcnt(4) lgkmcnt(0)
    v_mfma_f32_32x32x16_bf16 v[16:31], v[124:127], v[132:135], 0
    v_exp_f32 v48, v32
    v_exp_f32 v49, v33
    v_exp_f32 v50, v34
    v_exp_f32 v51, v35
    v_mfma_f32_32x32x16_bf16 v[16:31], v[116:119], v[136:139], v[16:31]
    v_exp_f32 v52, v36
    v_exp_f32 v53, v37
    v_exp_f32 v54, v38
    v_exp_f32 v55, v39
    v_mfma_f32_32x32x16_bf16 v[16:31], v[120:123], v[140:143], v[16:31]
    v_exp_f32 v56, v40
    v_exp_f32 v57, v41
    v_exp_f32 v58, v42
    v_exp_f32 v59, v43
    v_exp_f32 v60, v44
    s_mov_b32 m0, s70
    ds_read_b128 v[124:127], v236 offset:13824
    ds_read2st64_b64 v[128:131], v237 offset0:24 offset1:25
    ds_read_b128 v[116:119], v239 offset:6144
    ds_read_b128 v[120:123], v240 offset:6144
    v_exp_f32 v61, v45
    v_exp_f32 v62, v46
    v_exp_f32 v63, v47
    v_pk_fma_f32 v[36:37], v[36:37], v[48:49], v[36:37]
    v_pk_fma_f32 v[38:39], v[38:39], v[50:51], v[38:39]
    v_pk_add_f32 v[52:53], v[52:53], v[228:229]
    v_pk_add_f32 v[54:55], v[54:55], v[228:229]
    v_pk_fma_f32 v[44:45], v[44:45], v[56:57], v[44:45]
    v_pk_fma_f32 v[46:47], v[46:47], v[58:59], v[46:47]
    v_pk_add_f32 v[60:61], v[60:61], v[228:229]
    buffer_load_dwordx4 v247, s[48:51], 0 offen offset:0  lds
    buffer_load_dwordx4 v247, s[48:51], 0 offen offset:1024  lds
    v_pk_add_f32 v[62:63], v[62:63], v[228:229]
    v_pk_fma_f32 v[32:33], v[32:33], v[52:53], v[36:37]
    v_pk_fma_f32 v[34:35], v[34:35], v[54:55], v[38:39]
    v_pk_fma_f32 v[48:49], v[48:49], v[52:53], v[52:53]
    v_pk_fma_f32 v[50:51], v[50:51], v[54:55], v[54:55]
    v_pk_fma_f32 v[40:41], v[40:41], v[60:61], v[44:45]
    v_pk_fma_f32 v[42:43], v[42:43], v[62:63], v[46:47]
    v_pk_fma_f32 v[56:57], v[56:57], v[60:61], v[60:61]
    v_pk_fma_f32 v[58:59], v[58:59], v[62:63], v[62:63]
    v_pk_mul_f32 v[40:41], v[40:41], v[48:49]
    v_pk_mul_f32 v[42:43], v[42:43], v[50:51]
    v_pk_fma_f32 v[32:33], v[32:33], v[56:57], v[40:41]
    s_cmp_le_i32 s63, 25
    v_pk_fma_f32 v[34:35], v[34:35], v[58:59], v[42:43]
    v_pk_mul_f32 v[48:49], v[48:49], v[56:57]
    v_pk_mul_f32 v[50:51], v[50:51], v[58:59]
    s_cbranch_scc1 M_evf25
M_evrf25:
    v_rcp_f32 v48, v48
    v_rcp_f32 v49, v49
    v_rcp_f32 v50, v50
    v_rcp_f32 v51, v51
    v_pk_mul_f32 v[32:33], v[32:33], v[48:49]
    v_pk_mul_f32 v[34:35], v[34:35], v[50:51]
    v_cvt_pk_bf16_f32 v66, v32, v33
    v_cvt_pk_bf16_f32 v67, v34, v35
    s_branch M_fin
M_tailf0:
    s_lshl_b32 s3, s62, 9
    v_add_u32 v8, s3, v237
    v_mfma_f32_32x32x16_bf16 v[68:83], v[64:67], v[128:131], v[68:83]
    v_rcp_f32 v48, v48
    v_rcp_f32 v49, v49
    v_rcp_f32 v50, v50
    v_rcp_f32 v51, v51
    ds_read_b64 v[128:129], v8
    v_pk_mul_f32 v[16:17], v[16:17], v[48:49]
    v_pk_mul_f32 v[18:19], v[18:19], v[50:51]
    v_cvt_pk_bf16_f32 v64, v16, v17
    v_cvt_pk_bf16_f32 v65, v18, v19
    v_mov_b32 v130, 0
    v_mov_b32 v131, 0
    s_branch M_fin
M_tailf1:
    s_lshl_b32 s3, s62, 9
    v_add_u32 v8, s3, v237
    v_rcp_f32 v48, v48
    v_rcp_f32 v49, v49
    v_rcp_f32 v50, v50
    v_rcp_f32 v51, v51
    v_pk_mul_f32 v[32:33], v[32:33], v[48:49]
    v_pk_mul_f32 v[34:35], v[34:35], v[50:51]
    v_cvt_pk_bf16_f32 v66, v32, v33
    v_cvt_pk_bf16_f32 v67, v34, v35
M_fin:
    s_mov_b32 s62, s60
    s_cmp_eq_u32 s61, s60
    s_cbranch_scc0 M_fin2
    s_call_b64 s[94:95], M_rare
M_fin2:
    s_waitcnt lgkmcnt(0)
    v_mfma_f32_32x32x16_bf16 v[68:83], v[64:67], v[128:131], v[68:83]
    s_cmp_lg_u32 s67, 0
    s_nop 11
    s_cbranch_scc1 M_fin_hi
    v_pk_add_f32 v[84:85], v[84:85], v[68:69]
    v_pk_add_f32 v[86:87], v[86:87], v[70:71]
    v_pk_add_f32 v[88:89], v[88:89], v[72:73]
    v_pk_add_f32 v[90:91], v[90:91], v[74:75]
    v_pk_add_f32 v[92:93], v[92:93], v[76:77]
    v_pk_add_f32 v[94:95], v[94:95], v[78:79]
    v_pk_add_f32 v[96:97], v[96:97], v[80:81]
    v_pk_add_f32 v[98:99], v[98:99], v[82:83]
    s_branch M_bend
M_fin_hi:
    v_pk_add_f32 v[100:101], v[100:101], v[68:69]
    v_pk_add_f32 v[102:103], v[102:103], v[70:71]
    v_pk_add_f32 v[104:105], v[104:105], v[72:73]
    v_pk_add_f32 v[106:107], v[106:107], v[74:75]
    v_pk_add_f32 v[108:109], v[108:109], v[76:77]
    v_pk_add_f32 v[110:111], v[110:111], v[78:79]
    v_pk_add_f32 v[112:113], v[112:113], v[80:81]
    v_pk_add_f32 v[114:115], v[114:115], v[82:83]
M_bend:
    s_setprio 0
    s_cmp_lg_u32 s64, 0
    s_cbranch_scc1 M_next
M_epi:
    s_cmp_gt_u32 s60, 16
    s_cbranch_scc1 M_epi2
    buffer_load_dwordx4 v[176:179], v249, s[44:47], s26 offen offset:0 sc1
    buffer_load_dwordx4 v[180:183], v249, s[44:47], s26 offen offset:1024 sc1
    buffer_load_dwordx4 v[184:187], v249, s[44:47], s26 offen offset:2048 sc1
    buffer_load_dwordx4 v[188:191], v249, s[44:47], s26 offen offset:3072 sc1
    buffer_load_dwordx4 v[192:195], v249, s[44:47], s27 offen offset:0 sc1
    buffer_load_dwordx4 v[196:199], v249, s[44:47], s27 offen offset:1024 sc1
    buffer_load_dwordx4 v[200:203], v249, s[44:47], s27 offen offset:2048 sc1
    buffer_load_dwordx4 v[204:207], v249, s[44:47], s27 offen offset:3072 sc1
M_epi2:
    v_mov_b32 v228, s82
    v_mov_b32 v229, s82
    v_pk_mul_f32 v[84:85], v[84:85], v[228:229]
    v_pk_mul_f32 v[86:87], v[86:87], v[228:229]
    v_pk_mul_f32 v[88:89], v[88:89], v[228:229]
    v_pk_mul_f32 v[90:91], v[90:91], v[228:229]
    v_pk_mul_f32 v[92:93], v[92:93], v[228:229]
    v_pk_mul_f32 v[94:95], v[94:95], v[228:229]
    v_pk_mul_f32 v[96:97], v[96:97], v[228:229]
    v_pk_mul_f32 v[98:99], v[98:99], v[228:229]
    v_cvt_pk_bf16_f32 v16, v84, v85
    v_cvt_pk_bf16_f32 v17, v86, v87
    v_cvt_pk_bf16_f32 v18, v88, v89
    v_cvt_pk_bf16_f32 v19, v90, v91
    v_cvt_pk_bf16_f32 v20, v92, v93
    v_cvt_pk_bf16_f32 v21, v94, v95
    v_cvt_pk_bf16_f32 v22, v96, v97
    v_cvt_pk_bf16_f32 v23, v98, v99
    s_waitcnt vmcnt(0)
    ds_write_b128 v252, v[16:19]
    ds_write_b128 v253, v[20:23]
    v_pk_mul_f32 v[100:101], v[100:101], v[228:229]
    v_pk_mul_f32 v[102:103], v[102:103], v[228:229]
    v_pk_mul_f32 v[104:105], v[104:105], v[228:229]
    v_pk_mul_f32 v[106:107], v[106:107], v[228:229]
    v_pk_mul_f32 v[108:109], v[108:109], v[228:229]
    v_pk_mul_f32 v[110:111], v[110:111], v[228:229]
    v_pk_mul_f32 v[112:113], v[112:113], v[228:229]
    v_pk_mul_f32 v[114:115], v[114:115], v[228:229]
    v_cvt_pk_bf16_f32 v24, v100, v101
    v_cvt_pk_bf16_f32 v25, v102, v103
    v_cvt_pk_bf16_f32 v26, v104, v105
    v_cvt_pk_bf16_f32 v27, v106, v107
    v_cvt_pk_bf16_f32 v28, v108, v109
    v_cvt_pk_bf16_f32 v29, v110, v111
    v_cvt_pk_bf16_f32 v30, v112, v113
    v_cvt_pk_bf16_f32 v31, v114, v115
    ds_write_b128 v252, v[24:27] offset:2048
    ds_write_b128 v253, v[28:31] offset:2048
    s_mov_b32 s76, 4096
    s_mov_b32 s77, 8192
    s_waitcnt lgkmcnt(0)
    s_barrier
    ds_read_b128 v[48:51], v254 offset:0
    ds_read_b128 v[52:55], v254 offset:1024
    ds_read_b128 v[56:59], v254 offset:2048
    ds_read_b128 v[60:63], v254 offset:8192
    ds_read_b128 v[64:67], v254 offset:9216
    ds_read_b128 v[68:71], v254 offset:10240
    ds_read_b128 v[72:75], v254 offset:16384
    ds_read_b128 v[76:79], v254 offset:17408
    ds_read_b128 v[80:83], v254 offset:18432
    ds_read_b128 v[84:87], v254 offset:24576
    ds_read_b128 v[88:91], v254 offset:25600
    ds_read_b128 v[92:95], v254 offset:26624
    s_waitcnt lgkmcnt(11)
    v_mfma_f32_16x16x32_bf16 v[2:5], v[176:179], v[48:51], v[2:5]
    ds_read_b128 v[96:99], v254 offset:32768
    s_waitcnt lgkmcnt(11)
    v_mfma_f32_16x16x32_bf16 v[10:13], v[176:179], v[52:55], v[10:13]
    ds_read_b128 v[100:103], v254 offset:33792
    s_waitcnt lgkmcnt(11)
    v_mfma_f32_16x16x32_bf16 v[172:175], v[176:179], v[56:59], v[172:175]
    ds_read_b128 v[104:107], v254 offset:34816
    s_waitcnt lgkmcnt(11)
    v_mfma_f32_16x16x32_bf16 v[2:5], v[180:183], v[60:63], v[2:5]
    ds_read_b128 v[108:111], v254 offset:40960
    s_waitcnt lgkmcnt(11)
    v_mfma_f32_16x16x32_bf16 v[10:13], v[180:183], v[64:67], v[10:13]
    ds_read_b128 v[112:115], v254 offset:41984
    s_waitcnt lgkmcnt(11)
    v_mfma_f32_16x16x32_bf16 v[172:175], v[180:183], v[68:71], v[172:175]
    ds_read_b128 v[116:119], v254 offset:43008
    s_waitcnt lgkmcnt(11)
    v_mfma_f32_16x16x32_bf16 v[2:5], v[184:187], v[72:75], v[2:5]
    ds_read_b128 v[120:123], v254 offset:49152
    s_waitcnt lgkmcnt(11)
    v_mfma_f32_16x16x32_bf16 v[10:13], v[184:187], v[76:79], v[10:13]
    ds_read_b128 v[124:127], v254 offset:50176
    s_waitcnt lgkmcnt(11)
    v_mfma_f32_16x16x32_bf16 v[172:175], v[184:187], v[80:83], v[172:175]
    ds_read_b128 v[128:131], v254 offset:51200
    s_waitcnt lgkmcnt(11)
    v_mfma_f32_16x16x32_bf16 v[2:5], v[188:191], v[84:87], v[2:5]
    ds_read_b128 v[132:135], v254 offset:57344
    s_waitcnt lgkmcnt(11)
    v_mfma_f32_16x16x32_bf16 v[10:13], v[188:191], v[88:91], v[10:13]
    ds_read_b128 v[136:139], v254 offset:58368
    s_waitcnt lgkmcnt(11)
    v_mfma_f32_16x16x32_bf16 v[172:175], v[188:191], v[92:95], v[172:175]
    ds_read_b128 v[140:143], v254 offset:59392
    s_waitcnt lgkmcnt(11)
    v_mfma_f32_16x16x32_bf16 v[2:5], v[192:195], v[96:99], v[2:5]
    s_waitcnt lgkmcnt(10)
    v_mfma_f32_16x16x32_bf16 v[10:13], v[192:195], v[100:103], v[10:13]
    s_waitcnt lgkmcnt(9)
    v_mfma_f32_16x16x32_bf16 v[172:175], v[192:195], v[104:107], v[172:175]
    s_waitcnt lgkmcnt(8)
    v_mfma_f32_16x16x32_bf16 v[2:5], v[196:199], v[108:111], v[2:5]
    s_waitcnt lgkmcnt(7)
    v_mfma_f32_16x16x32_bf16 v[10:13], v[196:199], v[112:115], v[10:13]
    s_waitcnt lgkmcnt(6)
    v_mfma_f32_16x16x32_bf16 v[172:175], v[196:199], v[116:119], v[172:175]
    s_waitcnt lgkmcnt(5)
    v_mfma_f32_16x16x32_bf16 v[2:5], v[200:203], v[120:123], v[2:5]
    s_waitcnt lgkmcnt(4)
    v_mfma_f32_16x16x32_bf16 v[10:13], v[200:203], v[124:127], v[10:13]
    s_waitcnt lgkmcnt(3)
    v_mfma_f32_16x16x32_bf16 v[172:175], v[200:203], v[128:131], v[172:175]
    s_waitcnt lgkmcnt(2)
    v_mfma_f32_16x16x32_bf16 v[2:5], v[204:207], v[132:135], v[2:5]
    s_waitcnt lgkmcnt(1)
    v_mfma_f32_16x16x32_bf16 v[10:13], v[204:207], v[136:139], v[10:13]
    s_waitcnt lgkmcnt(0)
    v_mfma_f32_16x16x32_bf16 v[172:175], v[204:207], v[140:143], v[172:175]
    s_nop 5
    v_cvt_pk_bf16_f32 v16, v2, v3
    v_cvt_pk_bf16_f32 v17, v4, v5
    buffer_store_dwordx2 v[16:17], v255, s[28:31], 0 offen
    v_cvt_pk_bf16_f32 v18, v10, v11
    v_cvt_pk_bf16_f32 v19, v12, v13
    buffer_store_dwordx2 v[18:19], v255, s[28:31], s76 offen
    v_cvt_pk_bf16_f32 v20, v172, v173
    v_cvt_pk_bf16_f32 v21, v174, v175
    buffer_store_dwordx2 v[20:21], v255, s[28:31], s77 offen
M_end:
    s_endpgm
M_rare:
    s_cmp_eq_u32 s61, s62
    s_cbranch_scc0 M_rare2
    s_lshl_b32 s3, s62, 9
    v_add_u32 v8, s3, v237
    v_add_u32 v237, 512, v237
    s_mov_b32 s67, 1
    s_mov_b32 s61, 0x7fffffff
    s_bitcmp1_b32 s62, 0
    s_waitcnt lgkmcnt(0)
    s_cbranch_scc1 M_swo
    v_mfma_f32_32x32x16_bf16 v[68:83], v[64:67], v[128:131], v[68:83]
    v_mov_b32 v128, 0
    v_mov_b32 v129, 0
    ds_read_b64 v[130:131], v8
    s_nop 8
    v_pk_add_f32 v[84:85], v[84:85], v[68:69]
    v_pk_add_f32 v[86:87], v[86:87], v[70:71]
    v_pk_add_f32 v[88:89], v[88:89], v[72:73]
    v_pk_add_f32 v[90:91], v[90:91], v[74:75]
    v_pk_add_f32 v[92:93], v[92:93], v[76:77]
    v_pk_add_f32 v[94:95], v[94:95], v[78:79]
    v_pk_add_f32 v[96:97], v[96:97], v[80:81]
    v_pk_add_f32 v[98:99], v[98:99], v[82:83]
    s_waitcnt lgkmcnt(0)
    v_mfma_f32_32x32x16_bf16 v[68:83], v[64:67], v[128:131], 0
    v_mov_b32 v130, 0
    v_mov_b32 v131, 0
    s_branch M_rare2
M_swo:
    v_mov_b32 v130, 0
    v_mov_b32 v131, 0
    s_nop 1
    v_mfma_f32_32x32x16_bf16 v[68:83], v[64:67], v[128:131], v[68:83]
    v_mov_b32 v130, 0
    v_mov_b32 v131, 0
    ds_read_b64 v[128:129], v8
    s_nop 8
    v_pk_add_f32 v[84:85], v[84:85], v[68:69]
    v_pk_add_f32 v[86:87], v[86:87], v[70:71]
    v_pk_add_f32 v[88:89], v[88:89], v[72:73]
    v_pk_add_f32 v[90:91], v[90:91], v[74:75]
    v_pk_add_f32 v[92:93], v[92:93], v[76:77]
    v_pk_add_f32 v[94:95], v[94:95], v[78:79]
    v_pk_add_f32 v[96:97], v[96:97], v[80:81]
    v_pk_add_f32 v[98:99], v[98:99], v[82:83]
    s_waitcnt lgkmcnt(0)
    v_mfma_f32_32x32x16_bf16 v[68:83], v[64:67], v[128:131], 0
    v_mov_b32 v128, 0
    v_mov_b32 v129, 0
    ds_read_b64 v[130:131], v8 offset:512
M_rare2:
    s_cmp_le_i32 s72, s62
    s_cbranch_scc0 M_rare3
    s_setprio 0
    s_mov_b32 s72, 0x7fffffff
M_rare3:
    s_sub_u32 s3, s60, 1
    s_min_i32 s63, s3, s61
    s_min_i32 s63, s63, s72
    s_cmp_le_i32 s3, s62
    s_setpc_b64 s[94:95]
M_pbig:
    v_lshlrev_b32 v8, 7, v246
    v_mov_b32 v9, 0x10000
    s_mov_b32 s3, 4096
    s_mov_b64 exec, 0xffff
    buffer_atomic_add v9, v8, s[44:47], s3 offen sc1
    s_mov_b64 exec, -1
    s_branch M_pbigr
M_empty:
    s_mov_b32 s82, 0xa7317218
    v_and_b32 v8, 15, v246
    v_lshlrev_b32 v9, 2, v8
    ds_bpermute_b32 v6, v9, v244
    ds_bpermute_b32 v7, v9, v244 offset:64
    ds_bpermute_b32 v14, v9, v244 offset:128
    v_lshlrev_b32 v116, 16, v230
    v_and_b32 v117, 0xffff0000, v230
    v_lshlrev_b32 v118, 16, v231
    v_and_b32 v119, 0xffff0000, v231
    s_lshl_b32 s3, s58, 8
    s_mov_b32 s28, s20
    s_mov_b32 s29, s21
    s_mov_b32 s30, s3
    s_mov_b32 s31, 0x00020000
    s_waitcnt lgkmcnt(0)
    v_cvt_f32_u32 v6, v6
    v_cvt_f32_u32 v7, v7
    v_cvt_f32_u32 v14, v14
    v_pk_mul_f32 v[2:3], v[116:117], v[6:7] op_sel:[0,0] op_sel_hi:[1,0]
    v_pk_mul_f32 v[4:5], v[118:119], v[6:7] op_sel:[0,0] op_sel_hi:[1,0]
    v_pk_mul_f32 v[10:11], v[116:117], v[6:7] op_sel:[0,1] op_sel_hi:[1,1]
    v_pk_mul_f32 v[12:13], v[118:119], v[6:7] op_sel:[0,1] op_sel_hi:[1,1]
    v_pk_mul_f32 v[172:173], v[116:117], v[14:15] op_sel:[0,0] op_sel_hi:[1,0]
    v_pk_mul_f32 v[174:175], v[118:119], v[14:15] op_sel:[0,0] op_sel_hi:[1,0]
    s_branch M_bend
M_align:
    s_mov_b32 s73, -1
    s_mov_b32 s78, 0
    v_mov_b32 v13, v243
    v_readlane_b32 s76, v243, 0
    v_readlane_b32 s77, v243, 8
    s_nop 1
    s_sub_u32 s79, s78, s76
    v_cmp_le_u32 vcc, 0, v246
    v_add_u32 v10, s79, v243
    s_sub_u32 s77, s77, s76
    s_add_u32 s78, s78, s77
    v_cndmask_b32 v13, v13, v10, vcc
    s_add_u32 s78, s78, 63
    s_and_b32 s78, s78, 0xffffffc0
    v_readlane_b32 s76, v243, 8
    v_readlane_b32 s77, v243, 16
    s_nop 1
    s_sub_u32 s79, s78, s76
    v_cmp_le_u32 vcc, 8, v246
    v_add_u32 v10, s79, v243
    s_sub_u32 s77, s77, s76
    s_add_u32 s78, s78, s77
    v_cndmask_b32 v13, v13, v10, vcc
    s_add_u32 s78, s78, 63
    s_and_b32 s78, s78, 0xffffffc0
    v_readlane_b32 s76, v243, 16
    v_readlane_b32 s77, v243, 24
    s_nop 1
    s_sub_u32 s79, s78, s76
    v_cmp_le_u32 vcc, 16, v246
    v_add_u32 v10, s79, v243
    s_sub_u32 s77, s77, s76
    s_add_u32 s78, s78, s77
    v_cndmask_b32 v13, v13, v10, vcc
    s_add_u32 s78, s78, 63
    s_and_b32 s78, s78, 0xffffffc0
    v_readlane_b32 s76, v243, 24
    v_readlane_b32 s77, v243, 32
    s_nop 1
    s_sub_u32 s79, s78, s76
    v_cmp_le_u32 vcc, 24, v246
    v_add_u32 v10, s79, v243
    s_sub_u32 s77, s77, s76
    s_add_u32 s78, s78, s77
    v_cndmask_b32 v13, v13, v10, vcc
    s_add_u32 s78, s78, 63
    s_and_b32 s78, s78, 0xffffffc0
    v_readlane_b32 s76, v243, 32
    v_readlane_b32 s77, v243, 40
    s_nop 1
    s_sub_u32 s79, s78, s76
    v_cmp_le_u32 vcc, 32, v246
    v_add_u32 v10, s79, v243
    s_sub_u32 s77, s77, s76
    s_add_u32 s78, s78, s77
    v_cndmask_b32 v13, v13, v10, vcc
    s_mov_b32 s68, s78
    v_mov_b32 v243, v13
    s_nop 1
    s_branch M_derive
M_goslow:
    s_mov_b32 s64, 1
    s_mov_b32 s65, 0
    s_branch M_load
M_next:
    s_add_u32 s65, s65, 448
    s_cmp_ge_u32 s65, 160000
    s_cbranch_scc1 M_epi
M_load:
    s_mov_b32 s28, s10
    s_mov_b32 s29, s11
    s_mov_b32 s30, 640000
    s_mov_b32 s31, 0x00020000
    s_mov_b32 s32, s8
    s_mov_b32 s33, s9
    s_mov_b32 s34, 640000
    s_mov_b32 s35, 0x00020000
    v_add_u32 v8, s65, v0
    v_lshlrev_b32 v9, 2, v8
    s_waitcnt vmcnt(0) lgkmcnt(0)
    buffer_load_dword v10, v9, s[28:31], 0 offen
    buffer_load_dword v11, v9, s[32:35], 0 offen
    v_lshlrev_b32 v245, 3, v8
    v_mov_b32 v5, -1
    v_mov_b32 v6, -1
    v_mov_b32 v7, -1
    s_add_u32 s78, s65, 448
    s_min_u32 s78, s78, 160000
    s_waitcnt vmcnt(0)
    v_subrev_u32 v12, s57, v10
    v_cmp_gt_u32 vcc, s59, v12
    v_cmp_gt_u32 s[76:77], s78, v8
    v_and_b32 v10, 63, v10
    v_lshl_or_b32 v11, v10, 14, v11
    s_and_b64 vcc, vcc, s[76:77]
    s_nop 1
    v_cndmask_b32 v4, v5, v11, vcc
    s_barrier
    v_mov_b32 v40, 0
    v_mov_b32 v41, 0
    v_mov_b32 v42, 0
    v_mov_b32 v43, 0
    v_mov_b32 v44, 4194304
    v_mov_b32 v45, 4194304
    v_lshlrev_b32 v1, 3, v0
    v_add_u32 v1, 106496, v1
    ds_write_b64 v1, v[44:45]
    ds_write_b32 v250, v40
    ds_write_b32 v250, v40 offset:256
    v_lshlrev_b32 v1, 4, v0
    v_add_u32 v1, 65536, v1
    ds_write_b128 v1, v[40:43] offset:0
    ds_write_b128 v1, v[40:43] offset:8192
    ds_write_b128 v1, v[40:43] offset:16384
    ds_write_b128 v1, v[40:43] offset:24576
    ds_write_b128 v1, v[40:43] offset:32768
    s_waitcnt lgkmcnt(0)
    s_barrier
    s_branch M_recs
M_evf0:
    s_movk_i32 s62, 0
    s_call_b64 s[94:95], M_rare
    s_cbranch_scc1 M_tailf0
    s_branch M_evrf0
M_evf1:
    s_movk_i32 s62, 1
    s_call_b64 s[94:95], M_rare
    s_cbranch_scc1 M_tailf1
    s_branch M_evrf1
M_evf2:
    s_movk_i32 s62, 2
    s_call_b64 s[94:95], M_rare
    s_cbranch_scc1 M_tailf0
    s_branch M_evrf2
M_evf3:
    s_movk_i32 s62, 3
    s_call_b64 s[94:95], M_rare
    s_cbranch_scc1 M_tailf1
    s_branch M_evrf3
M_evf4:
    s_movk_i32 s62, 4
    s_call_b64 s[94:95], M_rare
    s_cbranch_scc1 M_tailf0
    s_branch M_evrf4
M_evf5:
    s_movk_i32 s62, 5
    s_call_b64 s[94:95], M_rare
    s_cbranch_scc1 M_tailf1
    s_branch M_evrf5
M_evf6:
    s_movk_i32 s62, 6
    s_call_b64 s[94:95], M_rare
    s_cbranch_scc1 M_tailf0
    s_branch M_evrf6
M_evf7:
    s_movk_i32 s62, 7
    s_call_b64 s[94:95], M_rare
    s_cbranch_scc1 M_tailf1
    s_branch M_evrf7
M_evf8:
    s_movk_i32 s62, 8
    s_call_b64 s[94:95], M_rare
    s_cbranch_scc1 M_tailf0
    s_branch M_evrf8
M_evf9:
    s_movk_i32 s62, 9
    s_call_b64 s[94:95], M_rare
    s_cbranch_scc1 M_tailf1
    s_branch M_evrf9
M_evf10:
    s_movk_i32 s62, 10
    s_call_b64 s[94:95], M_rare
    s_cbranch_scc1 M_tailf0
    s_branch M_evrf10
M_evf11:
    s_movk_i32 s62, 11
    s_call_b64 s[94:95], M_rare
    s_cbranch_scc1 M_tailf1
    s_branch M_evrf11
M_evf12:
    s_movk_i32 s62, 12
    s_call_b64 s[94:95], M_rare
    s_cbranch_scc1 M_tailf0
    s_branch M_evrf12
M_evf13:
    s_movk_i32 s62, 13
    s_call_b64 s[94:95], M_rare
    s_cbranch_scc1 M_tailf1
    s_branch M_evrf13
M_evf14:
    s_movk_i32 s62, 14
    s_call_b64 s[94:95], M_rare
    s_cbranch_scc1 M_tailf0
    s_branch M_evrf14
M_evf15:
    s_movk_i32 s62, 15
    s_call_b64 s[94:95], M_rare
    s_cbranch_scc1 M_tailf1
    s_branch M_evrf15
M_evf16:
    s_movk_i32 s62, 16
    s_call_b64 s[94:95], M_rare
    s_cbranch_scc1 M_tailf0
    s_branch M_evrf16
M_evf17:
    s_movk_i32 s62, 17
    s_call_b64 s[94:95], M_rare
    s_cbranch_scc1 M_tailf1
    s_branch M_evrf17
M_evf18:
    s_movk_i32 s62, 18
    s_call_b64 s[94:95], M_rare
    s_cbranch_scc1 M_tailf0
    s_branch M_evrf18
M_evf19:
    s_movk_i32 s62, 19
    s_call_b64 s[94:95], M_rare
    s_cbranch_scc1 M_tailf1
    s_branch M_evrf19
M_evf20:
    s_movk_i32 s62, 20
    s_call_b64 s[94:95], M_rare
    s_cbranch_scc1 M_tailf0
    s_branch M_evrf20
M_evf21:
    s_movk_i32 s62, 21
    s_call_b64 s[94:95], M_rare
    s_cbranch_scc1 M_tailf1
    s_branch M_evrf21
M_evf22:
    s_movk_i32 s62, 22
    s_call_b64 s[94:95], M_rare
    s_cbranch_scc1 M_tailf0
    s_branch M_evrf22
M_evf23:
    s_movk_i32 s62, 23
    s_call_b64 s[94:95], M_rare
    s_cbranch_scc1 M_tailf1
    s_branch M_evrf23
M_evf24:
    s_movk_i32 s62, 24
    s_call_b64 s[94:95], M_rare
    s_cbranch_scc1 M_tailf0
    s_branch M_evrf24
M_evf25:
    s_movk_i32 s62, 25
    s_call_b64 s[94:95], M_rare
    s_cbranch_scc1 M_tailf1
    s_branch M_evrf25
M_cpf1:
M_safe:
    .p2align 3
    s_waitcnt lgkmcnt(0)
    v_mfma_f32_32x32x16_bf16 v[32:47], v[124:127], v[132:135], 0
    v_exp_f32 v48, v16
    v_exp_f32 v49, v17
    v_exp_f32 v50, v18
    v_exp_f32 v51, v19
    v_exp_f32 v52, v20
    v_exp_f32 v53, v21
    v_exp_f32 v54, v22
    v_exp_f32 v55, v23
    v_exp_f32 v56, v24
    v_exp_f32 v57, v25
    v_exp_f32 v58, v26
    v_exp_f32 v59, v27
    v_exp_f32 v60, v28
    ds_read_b128 v[124:127], v236 offset:1024
    ds_read_b64_tr_b16 v[132:133], v145
    ds_read_b64_tr_b16 v[134:135], v145 offset:2368
    v_exp_f32 v61, v29
    v_exp_f32 v62, v30
    v_exp_f32 v63, v31
    buffer_load_dwordx4 v182, s[48:51], 0 offen offset:2048  lds
    buffer_load_dwordx4 v183, s[48:51], 0 offen offset:3072  lds
    s_mov_b32 m0, s66
    v_pk_fma_f32 v[48:49], v[48:49], v[228:229], v[228:229] clamp
    v_pk_fma_f32 v[50:51], v[50:51], v[228:229], v[228:229] clamp
    v_pk_fma_f32 v[52:53], v[52:53], v[228:229], v[228:229] clamp
    v_pk_fma_f32 v[54:55], v[54:55], v[228:229], v[228:229] clamp
    v_pk_fma_f32 v[56:57], v[56:57], v[228:229], v[228:229] clamp
    v_pk_fma_f32 v[58:59], v[58:59], v[228:229], v[228:229] clamp
    v_pk_fma_f32 v[60:61], v[60:61], v[228:229], v[228:229] clamp
    v_pk_fma_f32 v[62:63], v[62:63], v[228:229], v[228:229] clamp
    v_pk_mul_f32 v[16:17], v[16:17], v[52:53]
    v_pk_mul_f32 v[18:19], v[18:19], v[54:55]
    v_pk_fma_f32 v[16:17], v[20:21], v[48:49], v[16:17]
    v_pk_fma_f32 v[18:19], v[22:23], v[50:51], v[18:19]
    v_pk_mul_f32 v[48:49], v[48:49], v[52:53]
    v_pk_mul_f32 v[50:51], v[50:51], v[54:55]
    v_pk_mul_f32 v[24:25], v[24:25], v[60:61]
    v_and_b32 v8, 15, v246
    v_lshlrev_b32 v9, 2, v8
    ds_bpermute_b32 v6, v9, v244
    ds_bpermute_b32 v7, v9, v244 offset:64
    ds_bpermute_b32 v14, v9, v244 offset:128
    v_lshlrev_b32 v116, 16, v230
    v_and_b32 v117, 0xffff0000, v230
    v_lshlrev_b32 v118, 16, v231
    v_and_b32 v119, 0xffff0000, v231
    s_lshl_b32 s3, s58, 8
    s_mov_b32 s28, s20
    s_mov_b32 s29, s21
    s_mov_b32 s30, s3
    s_mov_b32 s31, 0x00020000
    s_waitcnt lgkmcnt(0)
    v_cvt_f32_u32 v6, v6
    v_cvt_f32_u32 v7, v7
    v_cvt_f32_u32 v14, v14
    v_pk_mul_f32 v[2:3], v[116:117], v[6:7] op_sel:[0,0] op_sel_hi:[1,0]
    v_pk_mul_f32 v[4:5], v[118:119], v[6:7] op_sel:[0,0] op_sel_hi:[1,0]
    v_pk_mul_f32 v[10:11], v[116:117], v[6:7] op_sel:[0,1] op_sel_hi:[1,1]
    v_pk_mul_f32 v[12:13], v[118:119], v[6:7] op_sel:[0,1] op_sel_hi:[1,1]
    v_pk_mul_f32 v[172:173], v[116:117], v[14:15] op_sel:[0,0] op_sel_hi:[1,0]
    v_pk_mul_f32 v[174:175], v[118:119], v[14:15] op_sel:[0,0] op_sel_hi:[1,0]
    s_waitcnt vmcnt(4)
    ds_read_b128 v[116:119], v239 offset:2048
    ds_read_b128 v[120:123], v240 offset:2048
    buffer_load_dwordx4 v184, s[48:51], 0 offen offset:0  lds
    buffer_load_dwordx4 v185, s[48:51], 0 offen offset:1024  lds
    v_pk_mul_f32 v[26:27], v[26:27], v[62:63]
    v_pk_fma_f32 v[24:25], v[28:29], v[56:57], v[24:25]
    s_cmp_le_i32 s63, 0
    v_pk_fma_f32 v[26:27], v[30:31], v[58:59], v[26:27]
    v_pk_mul_f32 v[56:57], v[56:57], v[60:61]
    v_pk_mul_f32 v[58:59], v[58:59], v[62:63]
    s_cbranch_scc1 M_evs0
M_evrs0:
    v_rcp_f32 v48, v48
    v_rcp_f32 v49, v49
    v_rcp_f32 v50, v50
    v_rcp_f32 v51, v51
    s_waitcnt lgkmcnt(0)
    v_mfma_f32_32x32x16_bf16 v[32:47], v[116:119], v[136:139], v[32:47]
    v_rcp_f32 v56, v56
    v_rcp_f32 v57, v57
    v_rcp_f32 v58, v58
    v_rcp_f32 v59, v59
    v_mfma_f32_32x32x16_bf16 v[32:47], v[120:123], v[140:143], v[32:47]
    buffer_load_dwordx4 v186, s[48:51], 0 offen offset:2048  lds
    buffer_load_dwordx4 v187, s[48:51], 0 offen offset:3072  lds
    v_pk_mul_f32 v[16:17], v[16:17], v[48:49]
    v_pk_mul_f32 v[18:19], v[18:19], v[50:51]
    v_pk_fma_f32 v[16:17], v[24:25], v[56:57], v[16:17]
    v_pk_fma_f32 v[18:19], v[26:27], v[58:59], v[18:19]
    v_cvt_pk_bf16_f32 v64, v16, v17
    v_cvt_pk_bf16_f32 v65, v18, v19
    s_nop 3
    s_waitcnt lgkmcnt(0)
    v_mfma_f32_32x32x16_bf16 v[16:31], v[124:127], v[132:135], 0
    v_exp_f32 v48, v32
    v_exp_f32 v49, v33
    v_exp_f32 v50, v34
    v_exp_f32 v51, v35
    v_exp_f32 v52, v36
    v_exp_f32 v53, v37
    v_exp_f32 v54, v38
    v_exp_f32 v55, v39
    v_exp_f32 v56, v40
    v_exp_f32 v57, v41
    v_exp_f32 v58, v42
    v_exp_f32 v59, v43
    v_exp_f32 v60, v44
    s_mov_b32 m0, s70
    ds_read_b128 v[124:127], v236 offset:1536
    ds_read2st64_b64 v[128:131], v237 offset0:0 offset1:1
    v_exp_f32 v61, v45
    v_exp_f32 v62, v46
    v_exp_f32 v63, v47
    v_pk_fma_f32 v[48:49], v[48:49], v[228:229], v[228:229] clamp
    v_pk_fma_f32 v[50:51], v[50:51], v[228:229], v[228:229] clamp
    v_pk_fma_f32 v[52:53], v[52:53], v[228:229], v[228:229] clamp
    v_pk_fma_f32 v[54:55], v[54:55], v[228:229], v[228:229] clamp
    v_pk_fma_f32 v[56:57], v[56:57], v[228:229], v[228:229] clamp
    v_pk_fma_f32 v[58:59], v[58:59], v[228:229], v[228:229] clamp
    v_pk_fma_f32 v[60:61], v[60:61], v[228:229], v[228:229] clamp
    v_pk_fma_f32 v[62:63], v[62:63], v[228:229], v[228:229] clamp
    v_pk_mul_f32 v[32:33], v[32:33], v[52:53]
    v_pk_mul_f32 v[34:35], v[34:35], v[54:55]
    v_pk_fma_f32 v[32:33], v[36:37], v[48:49], v[32:33]
    v_pk_fma_f32 v[34:35], v[38:39], v[50:51], v[34:35]
    v_pk_mul_f32 v[48:49], v[48:49], v[52:53]
    v_pk_mul_f32 v[50:51], v[50:51], v[54:55]
    v_pk_mul_f32 v[40:41], v[40:41], v[60:61]
    s_waitcnt vmcnt(6)
    ds_read_b128 v[116:119], v239 offset:4096
    ds_read_b128 v[120:123], v240 offset:4096
    v_pk_mul_f32 v[42:43], v[42:43], v[62:63]
    v_pk_fma_f32 v[40:41], v[44:45], v[56:57], v[40:41]
    s_cmp_le_i32 s63, 1
    v_pk_fma_f32 v[42:43], v[46:47], v[58:59], v[42:43]
    v_pk_mul_f32 v[56:57], v[56:57], v[60:61]
    v_pk_mul_f32 v[58:59], v[58:59], v[62:63]
    s_cbranch_scc1 M_evs1
M_evrs1:
    v_rcp_f32 v48, v48
    v_rcp_f32 v49, v49
    v_rcp_f32 v50, v50
    v_rcp_f32 v51, v51
    s_waitcnt lgkmcnt(0)
    v_mfma_f32_32x32x16_bf16 v[16:31], v[116:119], v[136:139], v[16:31]
    v_rcp_f32 v56, v56
    v_rcp_f32 v57, v57
    v_rcp_f32 v58, v58
    v_rcp_f32 v59, v59
    v_mfma_f32_32x32x16_bf16 v[16:31], v[120:123], v[140:143], v[16:31]
    buffer_load_dwordx4 v188, s[48:51], 0 offen offset:0  lds
    buffer_load_dwordx4 v189, s[48:51], 0 offen offset:1024  lds
    v_pk_mul_f32 v[32:33], v[32:33], v[48:49]
    v_pk_mul_f32 v[34:35], v[34:35], v[50:51]
    v_pk_fma_f32 v[32:33], v[40:41], v[56:57], v[32:33]
    v_pk_fma_f32 v[34:35], v[42:43], v[58:59], v[34:35]
    v_cvt_pk_bf16_f32 v66, v32, v33
    v_cvt_pk_bf16_f32 v67, v34, v35
    s_nop 3
    s_waitcnt lgkmcnt(0)
    v_mfma_f32_32x32x16_bf16 v[32:47], v[124:127], v[132:135], 0
    v_exp_f32 v48, v16
    v_exp_f32 v49, v17
    v_exp_f32 v50, v18
    v_exp_f32 v51, v19
    v_exp_f32 v52, v20
    v_exp_f32 v53, v21
    v_exp_f32 v54, v22
    v_exp_f32 v55, v23
    v_exp_f32 v56, v24
    v_exp_f32 v57, v25
    v_exp_f32 v58, v26
    v_exp_f32 v59, v27
    v_exp_f32 v60, v28
    ds_read_b128 v[124:127], v236 offset:2048
    ds_read_b64_tr_b16 v[132:133], v146
    ds_read_b64_tr_b16 v[134:135], v146 offset:2368
    v_exp_f32 v61, v29
    v_exp_f32 v62, v30
    v_exp_f32 v63, v31
    v_pk_fma_f32 v[48:49], v[48:49], v[228:229], v[228:229] clamp
    v_pk_fma_f32 v[50:51], v[50:51], v[228:229], v[228:229] clamp
    v_pk_fma_f32 v[52:53], v[52:53], v[228:229], v[228:229] clamp
    v_pk_fma_f32 v[54:55], v[54:55], v[228:229], v[228:229] clamp
    v_pk_fma_f32 v[56:57], v[56:57], v[228:229], v[228:229] clamp
    v_pk_fma_f32 v[58:59], v[58:59], v[228:229], v[228:229] clamp
    v_pk_fma_f32 v[60:61], v[60:61], v[228:229], v[228:229] clamp
    v_pk_fma_f32 v[62:63], v[62:63], v[228:229], v[228:229] clamp
    v_pk_mul_f32 v[16:17], v[16:17], v[52:53]
    v_pk_mul_f32 v[18:19], v[18:19], v[54:55]
    v_pk_fma_f32 v[16:17], v[20:21], v[48:49], v[16:17]
    v_pk_fma_f32 v[18:19], v[22:23], v[50:51], v[18:19]
    v_pk_mul_f32 v[48:49], v[48:49], v[52:53]
    v_pk_mul_f32 v[50:51], v[50:51], v[54:55]
    v_pk_mul_f32 v[24:25], v[24:25], v[60:61]
    s_waitcnt vmcnt(6)
    ds_read_b128 v[116:119], v239 offset:6144
    ds_read_b128 v[120:123], v240 offset:6144
    v_pk_mul_f32 v[26:27], v[26:27], v[62:63]
    v_pk_fma_f32 v[24:25], v[28:29], v[56:57], v[24:25]
    s_cmp_le_i32 s63, 2
    v_pk_fma_f32 v[26:27], v[30:31], v[58:59], v[26:27]
    v_pk_mul_f32 v[56:57], v[56:57], v[60:61]
    v_pk_mul_f32 v[58:59], v[58:59], v[62:63]
    s_cbranch_scc1 M_evs2
M_evrs2:
    v_mfma_f32_32x32x16_bf16 v[68:83], v[64:67], v[128:131], v[68:83]
    v_rcp_f32 v48, v48
    v_rcp_f32 v49, v49
    v_rcp_f32 v50, v50
    v_rcp_f32 v51, v51
    s_waitcnt lgkmcnt(0)
    v_mfma_f32_32x32x16_bf16 v[32:47], v[116:119], v[136:139], v[32:47]
    v_rcp_f32 v56, v56
    v_rcp_f32 v57, v57
    v_rcp_f32 v58, v58
    v_rcp_f32 v59, v59
    v_mfma_f32_32x32x16_bf16 v[32:47], v[120:123], v[140:143], v[32:47]
    buffer_load_dwordx4 v190, s[48:51], 0 offen offset:2048  lds
    buffer_load_dwordx4 v191, s[48:51], 0 offen offset:3072  lds
    s_waitcnt vmcnt(6)
    ds_read_b128 v[116:119], v239 offset:0
    ds_read_b128 v[120:123], v240 offset:0
    v_pk_mul_f32 v[16:17], v[16:17], v[48:49]
    v_pk_mul_f32 v[18:19], v[18:19], v[50:51]
    v_pk_fma_f32 v[16:17], v[24:25], v[56:57], v[16:17]
    v_pk_fma_f32 v[18:19], v[26:27], v[58:59], v[18:19]
    v_cvt_pk_bf16_f32 v64, v16, v17
    v_cvt_pk_bf16_f32 v65, v18, v19
    s_nop 3
    s_waitcnt lgkmcnt(0)
    v_mfma_f32_32x32x16_bf16 v[16:31], v[124:127], v[132:135], 0
    v_exp_f32 v48, v32
    v_exp_f32 v49, v33
    v_exp_f32 v50, v34
    v_exp_f32 v51, v35
    v_mfma_f32_32x32x16_bf16 v[16:31], v[116:119], v[136:139], v[16:31]
    v_exp_f32 v52, v36
    v_exp_f32 v53, v37
    v_exp_f32 v54, v38
    v_exp_f32 v55, v39
    v_mfma_f32_32x32x16_bf16 v[16:31], v[120:123], v[140:143], v[16:31]
    v_exp_f32 v56, v40
    v_exp_f32 v57, v41
    v_exp_f32 v58, v42
    v_exp_f32 v59, v43
    v_exp_f32 v60, v44
    s_mov_b32 m0, s66
    ds_read_b128 v[124:127], v236 offset:2560
    ds_read2st64_b64 v[128:131], v237 offset0:2 offset1:3
    v_exp_f32 v61, v45
    v_exp_f32 v62, v46
    v_exp_f32 v63, v47
    v_pk_fma_f32 v[48:49], v[48:49], v[228:229], v[228:229] clamp
    v_pk_fma_f32 v[50:51], v[50:51], v[228:229], v[228:229] clamp
    v_pk_fma_f32 v[52:53], v[52:53], v[228:229], v[228:229] clamp
    v_pk_fma_f32 v[54:55], v[54:55], v[228:229], v[228:229] clamp
    v_pk_fma_f32 v[56:57], v[56:57], v[228:229], v[228:229] clamp
    v_pk_fma_f32 v[58:59], v[58:59], v[228:229], v[228:229] clamp
    v_pk_fma_f32 v[60:61], v[60:61], v[228:229], v[228:229] clamp
    v_pk_fma_f32 v[62:63], v[62:63], v[228:229], v[228:229] clamp
    v_pk_mul_f32 v[32:33], v[32:33], v[52:53]
    v_pk_mul_f32 v[34:35], v[34:35], v[54:55]
    v_pk_fma_f32 v[32:33], v[36:37], v[48:49], v[32:33]
    v_pk_fma_f32 v[34:35], v[38:39], v[50:51], v[34:35]
    v_pk_mul_f32 v[48:49], v[48:49], v[52:53]
    s_waitcnt vmcnt(4)
    ds_read_b128 v[116:119], v239 offset:2048
    ds_read_b128 v[120:123], v240 offset:2048
    buffer_load_dwordx4 v192, s[48:51], 0 offen offset:0  lds
    buffer_load_dwordx4 v193, s[48:51], 0 offen offset:1024  lds
    v_pk_mul_f32 v[50:51], v[50:51], v[54:55]
    v_pk_mul_f32 v[40:41], v[40:41], v[60:61]
    v_pk_mul_f32 v[42:43], v[42:43], v[62:63]
    v_pk_fma_f32 v[40:41], v[44:45], v[56:57], v[40:41]
    s_cmp_le_i32 s63, 3
    v_pk_fma_f32 v[42:43], v[46:47], v[58:59], v[42:43]
    v_pk_mul_f32 v[56:57], v[56:57], v[60:61]
    v_pk_mul_f32 v[58:59], v[58:59], v[62:63]
    s_cbranch_scc1 M_evs3
M_evrs3:
    v_rcp_f32 v48, v48
    v_rcp_f32 v49, v49
    v_rcp_f32 v50, v50
    v_rcp_f32 v51, v51
    v_rcp_f32 v56, v56
    v_rcp_f32 v57, v57
    v_rcp_f32 v58, v58
    v_rcp_f32 v59, v59
    v_pk_mul_f32 v[32:33], v[32:33], v[48:49]
    v_pk_mul_f32 v[34:35], v[34:35], v[50:51]
    v_pk_fma_f32 v[32:33], v[40:41], v[56:57], v[32:33]
    v_pk_fma_f32 v[34:35], v[42:43], v[58:59], v[34:35]
    v_cvt_pk_bf16_f32 v66, v32, v33
    v_cvt_pk_bf16_f32 v67, v34, v35
    s_waitcnt lgkmcnt(0)
    v_mfma_f32_32x32x16_bf16 v[32:47], v[124:127], v[132:135], 0
    v_exp_f32 v48, v16
    v_exp_f32 v49, v17
    v_exp_f32 v50, v18
    v_exp_f32 v51, v19
    v_mfma_f32_32x32x16_bf16 v[32:47], v[116:119], v[136:139], v[32:47]
    v_exp_f32 v52, v20
    v_exp_f32 v53, v21
    v_exp_f32 v54, v22
    v_exp_f32 v55, v23
    v_mfma_f32_32x32x16_bf16 v[32:47], v[120:123], v[140:143], v[32:47]
    v_exp_f32 v56, v24
    v_exp_f32 v57, v25
    v_exp_f32 v58, v26
    v_exp_f32 v59, v27
    v_exp_f32 v60, v28
    ds_read_b128 v[124:127], v236 offset:3072
    ds_read_b64_tr_b16 v[132:133], v147
    ds_read_b64_tr_b16 v[134:135], v147 offset:2368
    v_exp_f32 v61, v29
    v_exp_f32 v62, v30
    v_exp_f32 v63, v31
    v_pk_fma_f32 v[48:49], v[48:49], v[228:229], v[228:229] clamp
    v_pk_fma_f32 v[50:51], v[50:51], v[228:229], v[228:229] clamp
    v_pk_fma_f32 v[52:53], v[52:53], v[228:229], v[228:229] clamp
    v_pk_fma_f32 v[54:55], v[54:55], v[228:229], v[228:229] clamp
    v_pk_fma_f32 v[56:57], v[56:57], v[228:229], v[228:229] clamp
    v_pk_fma_f32 v[58:59], v[58:59], v[228:229], v[228:229] clamp
    v_pk_fma_f32 v[60:61], v[60:61], v[228:229], v[228:229] clamp
    v_pk_fma_f32 v[62:63], v[62:63], v[228:229], v[228:229] clamp
    v_pk_mul_f32 v[16:17], v[16:17], v[52:53]
    v_pk_mul_f32 v[18:19], v[18:19], v[54:55]
    v_pk_fma_f32 v[16:17], v[20:21], v[48:49], v[16:17]
    v_pk_fma_f32 v[18:19], v[22:23], v[50:51], v[18:19]
    v_pk_mul_f32 v[48:49], v[48:49], v[52:53]
    s_waitcnt vmcnt(4)
    ds_read_b128 v[116:119], v239 offset:4096
    ds_read_b128 v[120:123], v240 offset:4096
    buffer_load_dwordx4 v194, s[48:51], 0 offen offset:2048  lds
    buffer_load_dwordx4 v195, s[48:51], 0 offen offset:3072  lds
    v_pk_mul_f32 v[50:51], v[50:51], v[54:55]
    v_pk_mul_f32 v[24:25], v[24:25], v[60:61]
    v_pk_mul_f32 v[26:27], v[26:27], v[62:63]
    v_pk_fma_f32 v[24:25], v[28:29], v[56:57], v[24:25]
    s_cmp_le_i32 s63, 4
    v_pk_fma_f32 v[26:27], v[30:31], v[58:59], v[26:27]
    v_pk_mul_f32 v[56:57], v[56:57], v[60:61]
    v_pk_mul_f32 v[58:59], v[58:59], v[62:63]
    s_cbranch_scc1 M_evs4
M_evrs4:
    v_mfma_f32_32x32x16_bf16 v[68:83], v[64:67], v[128:131], v[68:83]
    v_rcp_f32 v48, v48
    v_rcp_f32 v49, v49
    v_rcp_f32 v50, v50
    v_rcp_f32 v51, v51
    v_rcp_f32 v56, v56
    v_rcp_f32 v57, v57
    v_rcp_f32 v58, v58
    v_rcp_f32 v59, v59
    v_pk_mul_f32 v[16:17], v[16:17], v[48:49]
    v_pk_mul_f32 v[18:19], v[18:19], v[50:51]
    v_pk_fma_f32 v[16:17], v[24:25], v[56:57], v[16:17]
    v_pk_fma_f32 v[18:19], v[26:27], v[58:59], v[18:19]
    v_cvt_pk_bf16_f32 v64, v16, v17
    v_cvt_pk_bf16_f32 v65, v18, v19
    s_waitcnt vmcnt(4) lgkmcnt(0)
    v_mfma_f32_32x32x16_bf16 v[16:31], v[124:127], v[132:135], 0
    v_exp_f32 v48, v32
    v_exp_f32 v49, v33
    v_exp_f32 v50, v34
    v_exp_f32 v51, v35
    v_mfma_f32_32x32x16_bf16 v[16:31], v[116:119], v[136:139], v[16:31]
    v_exp_f32 v52, v36
    v_exp_f32 v53, v37
    v_exp_f32 v54, v38
    v_exp_f32 v55, v39
    v_mfma_f32_32x32x16_bf16 v[16:31], v[120:123], v[140:143], v[16:31]
    v_exp_f32 v56, v40
    v_exp_f32 v57, v41
    v_exp_f32 v58, v42
    v_exp_f32 v59, v43
    v_exp_f32 v60, v44
    s_mov_b32 m0, s70
    ds_read_b128 v[124:127], v236 offset:3584
    ds_read2st64_b64 v[128:131], v237 offset0:4 offset1:5
    ds_read_b128 v[116:119], v239 offset:6144
    ds_read_b128 v[120:123], v240 offset:6144
    v_exp_f32 v61, v45
    v_exp_f32 v62, v46
    v_exp_f32 v63, v47
    v_pk_fma_f32 v[48:49], v[48:49], v[228:229], v[228:229] clamp
    v_pk_fma_f32 v[50:51], v[50:51], v[228:229], v[228:229] clamp
    v_pk_fma_f32 v[52:53], v[52:53], v[228:229], v[228:229] clamp
    v_pk_fma_f32 v[54:55], v[54:55], v[228:229], v[228:229] clamp
    v_pk_fma_f32 v[56:57], v[56:57], v[228:229], v[228:229] clamp
    v_pk_fma_f32 v[58:59], v[58:59], v[228:229], v[228:229] clamp
    v_pk_fma_f32 v[60:61], v[60:61], v[228:229], v[228:229] clamp
    buffer_load_dwordx4 v196, s[48:51], 0 offen offset:0  lds
    buffer_load_dwordx4 v197, s[48:51], 0 offen offset:1024  lds
    v_pk_fma_f32 v[62:63], v[62:63], v[228:229], v[228:229] clamp
    v_pk_mul_f32 v[32:33], v[32:33], v[52:53]
    v_pk_mul_f32 v[34:35], v[34:35], v[54:55]
    v_pk_fma_f32 v[32:33], v[36:37], v[48:49], v[32:33]
    v_pk_fma_f32 v[34:35], v[38:39], v[50:51], v[34:35]
    v_pk_mul_f32 v[48:49], v[48:49], v[52:53]
    v_pk_mul_f32 v[50:51], v[50:51], v[54:55]
    v_pk_mul_f32 v[40:41], v[40:41], v[60:61]
    v_pk_mul_f32 v[42:43], v[42:43], v[62:63]
    v_pk_fma_f32 v[40:41], v[44:45], v[56:57], v[40:41]
    s_cmp_le_i32 s63, 5
    v_pk_fma_f32 v[42:43], v[46:47], v[58:59], v[42:43]
    v_pk_mul_f32 v[56:57], v[56:57], v[60:61]
    v_pk_mul_f32 v[58:59], v[58:59], v[62:63]
    s_cbranch_scc1 M_evs5
M_evrs5:
    v_rcp_f32 v48, v48
    v_rcp_f32 v49, v49
    v_rcp_f32 v50, v50
    v_rcp_f32 v51, v51
    v_rcp_f32 v56, v56
    v_rcp_f32 v57, v57
    v_rcp_f32 v58, v58
    v_rcp_f32 v59, v59
    v_pk_mul_f32 v[32:33], v[32:33], v[48:49]
    v_pk_mul_f32 v[34:35], v[34:35], v[50:51]
    v_pk_fma_f32 v[32:33], v[40:41], v[56:57], v[32:33]
    v_pk_fma_f32 v[34:35], v[42:43], v[58:59], v[34:35]
    v_cvt_pk_bf16_f32 v66, v32, v33
    v_cvt_pk_bf16_f32 v67, v34, v35
    s_waitcnt vmcnt(4) lgkmcnt(0)
    v_mfma_f32_32x32x16_bf16 v[32:47], v[124:127], v[132:135], 0
    v_exp_f32 v48, v16
    v_exp_f32 v49, v17
    v_exp_f32 v50, v18
    v_exp_f32 v51, v19
    v_mfma_f32_32x32x16_bf16 v[32:47], v[116:119], v[136:139], v[32:47]
    v_exp_f32 v52, v20
    v_exp_f32 v53, v21
    v_exp_f32 v54, v22
    v_exp_f32 v55, v23
    v_mfma_f32_32x32x16_bf16 v[32:47], v[120:123], v[140:143], v[32:47]
    v_exp_f32 v56, v24
    v_exp_f32 v57, v25
    v_exp_f32 v58, v26
    v_exp_f32 v59, v27
    v_exp_f32 v60, v28
    ds_read_b128 v[124:127], v236 offset:4096
    ds_read_b64_tr_b16 v[132:133], v148
    ds_read_b64_tr_b16 v[134:135], v148 offset:2368
    ds_read_b128 v[116:119], v239 offset:0
    ds_read_b128 v[120:123], v240 offset:0
    v_exp_f32 v61, v29
    v_exp_f32 v62, v30
    v_exp_f32 v63, v31
    v_pk_fma_f32 v[48:49], v[48:49], v[228:229], v[228:229] clamp
    v_pk_fma_f32 v[50:51], v[50:51], v[228:229], v[228:229] clamp
    v_pk_fma_f32 v[52:53], v[52:53], v[228:229], v[228:229] clamp
    v_pk_fma_f32 v[54:55], v[54:55], v[228:229], v[228:229] clamp
    v_pk_fma_f32 v[56:57], v[56:57], v[228:229], v[228:229] clamp
    v_pk_fma_f32 v[58:59], v[58:59], v[228:229], v[228:229] clamp
    v_pk_fma_f32 v[60:61], v[60:61], v[228:229], v[228:229] clamp
    buffer_load_dwordx4 v198, s[48:51], 0 offen offset:2048  lds
    buffer_load_dwordx4 v199, s[48:51], 0 offen offset:3072  lds
    v_pk_fma_f32 v[62:63], v[62:63], v[228:229], v[228:229] clamp
    v_pk_mul_f32 v[16:17], v[16:17], v[52:53]
    v_pk_mul_f32 v[18:19], v[18:19], v[54:55]
    v_pk_fma_f32 v[16:17], v[20:21], v[48:49], v[16:17]
    v_pk_fma_f32 v[18:19], v[22:23], v[50:51], v[18:19]
    v_pk_mul_f32 v[48:49], v[48:49], v[52:53]
    v_pk_mul_f32 v[50:51], v[50:51], v[54:55]
    v_pk_mul_f32 v[24:25], v[24:25], v[60:61]
    v_pk_mul_f32 v[26:27], v[26:27], v[62:63]
    v_pk_fma_f32 v[24:25], v[28:29], v[56:57], v[24:25]
    s_cmp_le_i32 s63, 6
    v_pk_fma_f32 v[26:27], v[30:31], v[58:59], v[26:27]
    v_pk_mul_f32 v[56:57], v[56:57], v[60:61]
    v_pk_mul_f32 v[58:59], v[58:59], v[62:63]
    s_cbranch_scc1 M_evs6
M_evrs6:
    v_mfma_f32_32x32x16_bf16 v[68:83], v[64:67], v[128:131], v[68:83]
    v_rcp_f32 v48, v48
    v_rcp_f32 v49, v49
    v_rcp_f32 v50, v50
    v_rcp_f32 v51, v51
    v_rcp_f32 v56, v56
    v_rcp_f32 v57, v57
    v_rcp_f32 v58, v58
    v_rcp_f32 v59, v59
    v_pk_mul_f32 v[16:17], v[16:17], v[48:49]
    v_pk_mul_f32 v[18:19], v[18:19], v[50:51]
    v_pk_fma_f32 v[16:17], v[24:25], v[56:57], v[16:17]
    v_pk_fma_f32 v[18:19], v[26:27], v[58:59], v[18:19]
    v_cvt_pk_bf16_f32 v64, v16, v17
    v_cvt_pk_bf16_f32 v65, v18, v19
    s_waitcnt vmcnt(4) lgkmcnt(0)
    v_mfma_f32_32x32x16_bf16 v[16:31], v[124:127], v[132:135], 0
    v_exp_f32 v48, v32
    v_exp_f32 v49, v33
    v_exp_f32 v50, v34
    v_exp_f32 v51, v35
    v_mfma_f32_32x32x16_bf16 v[16:31], v[116:119], v[136:139], v[16:31]
    v_exp_f32 v52, v36
    v_exp_f32 v53, v37
    v_exp_f32 v54, v38
    v_exp_f32 v55, v39
    v_mfma_f32_32x32x16_bf16 v[16:31], v[120:123], v[140:143], v[16:31]
    v_exp_f32 v56, v40
    v_exp_f32 v57, v41
    v_exp_f32 v58, v42
    v_exp_f32 v59, v43
    v_exp_f32 v60, v44
    s_mov_b32 m0, s66
    ds_read_b128 v[124:127], v236 offset:4608
    ds_read2st64_b64 v[128:131], v237 offset0:6 offset1:7
    ds_read_b128 v[116:119], v239 offset:2048
    ds_read_b128 v[120:123], v240 offset:2048
    v_exp_f32 v61, v45
    v_exp_f32 v62, v46
    v_exp_f32 v63, v47
    v_pk_fma_f32 v[48:49], v[48:49], v[228:229], v[228:229] clamp
    v_pk_fma_f32 v[50:51], v[50:51], v[228:229], v[228:229] clamp
    v_pk_fma_f32 v[52:53], v[52:53], v[228:229], v[228:229] clamp
    v_pk_fma_f32 v[54:55], v[54:55], v[228:229], v[228:229] clamp
    v_pk_fma_f32 v[56:57], v[56:57], v[228:229], v[228:229] clamp
    v_pk_fma_f32 v[58:59], v[58:59], v[228:229], v[228:229] clamp
    v_pk_fma_f32 v[60:61], v[60:61], v[228:229], v[228:229] clamp
    buffer_load_dwordx4 v200, s[48:51], 0 offen offset:0  lds
    buffer_load_dwordx4 v201, s[48:51], 0 offen offset:1024  lds
    v_pk_fma_f32 v[62:63], v[62:63], v[228:229], v[228:229] clamp
    v_pk_mul_f32 v[32:33], v[32:33], v[52:53]
    v_pk_mul_f32 v[34:35], v[34:35], v[54:55]
    v_pk_fma_f32 v[32:33], v[36:37], v[48:49], v[32:33]
    v_pk_fma_f32 v[34:35], v[38:39], v[50:51], v[34:35]
    v_pk_mul_f32 v[48:49], v[48:49], v[52:53]
    v_pk_mul_f32 v[50:51], v[50:51], v[54:55]
    v_pk_mul_f32 v[40:41], v[40:41], v[60:61]
    v_pk_mul_f32 v[42:43], v[42:43], v[62:63]
    v_pk_fma_f32 v[40:41], v[44:45], v[56:57], v[40:41]
    s_cmp_le_i32 s63, 7
    v_pk_fma_f32 v[42:43], v[46:47], v[58:59], v[42:43]
    v_pk_mul_f32 v[56:57], v[56:57], v[60:61]
    v_pk_mul_f32 v[58:59], v[58:59], v[62:63]
    s_cbranch_scc1 M_evs7
M_evrs7:
    v_rcp_f32 v48, v48
    v_rcp_f32 v49, v49
    v_rcp_f32 v50, v50
    v_rcp_f32 v51, v51
    v_rcp_f32 v56, v56
    v_rcp_f32 v57, v57
    v_rcp_f32 v58, v58
    v_rcp_f32 v59, v59
    v_pk_mul_f32 v[32:33], v[32:33], v[48:49]
    v_pk_mul_f32 v[34:35], v[34:35], v[50:51]
    v_pk_fma_f32 v[32:33], v[40:41], v[56:57], v[32:33]
    v_pk_fma_f32 v[34:35], v[42:43], v[58:59], v[34:35]
    v_cvt_pk_bf16_f32 v66, v32, v33
    v_cvt_pk_bf16_f32 v67, v34, v35
    s_waitcnt vmcnt(4) lgkmcnt(0)
    v_mfma_f32_32x32x16_bf16 v[32:47], v[124:127], v[132:135], 0
    v_exp_f32 v48, v16
    v_exp_f32 v49, v17
    v_exp_f32 v50, v18
    v_exp_f32 v51, v19
    v_mfma_f32_32x32x16_bf16 v[32:47], v[116:119], v[136:139], v[32:47]
    v_exp_f32 v52, v20
    v_exp_f32 v53, v21
    v_exp_f32 v54, v22
    v_exp_f32 v55, v23
    v_mfma_f32_32x32x16_bf16 v[32:47], v[120:123], v[140:143], v[32:47]
    v_exp_f32 v56, v24
    v_exp_f32 v57, v25
    v_exp_f32 v58, v26
    v_exp_f32 v59, v27
    v_exp_f32 v60, v28
    ds_read_b128 v[124:127], v236 offset:5120
    ds_read_b64_tr_b16 v[132:133], v149
    ds_read_b64_tr_b16 v[134:135], v149 offset:2368
    ds_read_b128 v[116:119], v239 offset:4096
    ds_read_b128 v[120:123], v240 offset:4096
    v_exp_f32 v61, v29
    v_exp_f32 v62, v30
    v_exp_f32 v63, v31
    v_pk_fma_f32 v[48:49], v[48:49], v[228:229], v[228:229] clamp
    v_pk_fma_f32 v[50:51], v[50:51], v[228:229], v[228:229] clamp
    v_pk_fma_f32 v[52:53], v[52:53], v[228:229], v[228:229] clamp
    v_pk_fma_f32 v[54:55], v[54:55], v[228:229], v[228:229] clamp
    v_pk_fma_f32 v[56:57], v[56:57], v[228:229], v[228:229] clamp
    v_pk_fma_f32 v[58:59], v[58:59], v[228:229], v[228:229] clamp
    v_pk_fma_f32 v[60:61], v[60:61], v[228:229], v[228:229] clamp
    buffer_load_dwordx4 v202, s[48:51], 0 offen offset:2048  lds
    buffer_load_dwordx4 v203, s[48:51], 0 offen offset:3072  lds
    buffer_load_dwordx4 v[176:179], v249, s[44:47], s26 offen offset:0 sc1
    v_pk_fma_f32 v[62:63], v[62:63], v[228:229], v[228:229] clamp
    v_pk_mul_f32 v[16:17], v[16:17], v[52:53]
    v_pk_mul_f32 v[18:19], v[18:19], v[54:55]
    v_pk_fma_f32 v[16:17], v[20:21], v[48:49], v[16:17]
    v_pk_fma_f32 v[18:19], v[22:23], v[50:51], v[18:19]
    v_pk_mul_f32 v[48:49], v[48:49], v[52:53]
    v_pk_mul_f32 v[50:51], v[50:51], v[54:55]
    v_pk_mul_f32 v[24:25], v[24:25], v[60:61]
    v_pk_mul_f32 v[26:27], v[26:27], v[62:63]
    v_pk_fma_f32 v[24:25], v[28:29], v[56:57], v[24:25]
    s_cmp_le_i32 s63, 8
    v_pk_fma_f32 v[26:27], v[30:31], v[58:59], v[26:27]
    v_pk_mul_f32 v[56:57], v[56:57], v[60:61]
    v_pk_mul_f32 v[58:59], v[58:59], v[62:63]
    s_cbranch_scc1 M_evs8
M_evrs8:
    v_mfma_f32_32x32x16_bf16 v[68:83], v[64:67], v[128:131], v[68:83]
    v_rcp_f32 v48, v48
    v_rcp_f32 v49, v49
    v_rcp_f32 v50, v50
    v_rcp_f32 v51, v51
    v_rcp_f32 v56, v56
    v_rcp_f32 v57, v57
    v_rcp_f32 v58, v58
    v_rcp_f32 v59, v59
    v_pk_mul_f32 v[16:17], v[16:17], v[48:49]
    v_pk_mul_f32 v[18:19], v[18:19], v[50:51]
    v_pk_fma_f32 v[16:17], v[24:25], v[56:57], v[16:17]
    v_pk_fma_f32 v[18:19], v[26:27], v[58:59], v[18:19]
    v_cvt_pk_bf16_f32 v64, v16, v17
    v_cvt_pk_bf16_f32 v65, v18, v19
    s_waitcnt vmcnt(5) lgkmcnt(0)
    v_mfma_f32_32x32x16_bf16 v[16:31], v[124:127], v[132:135], 0
    v_exp_f32 v48, v32
    v_exp_f32 v49, v33
    v_exp_f32 v50, v34
    v_exp_f32 v51, v35
    v_mfma_f32_32x32x16_bf16 v[16:31], v[116:119], v[136:139], v[16:31]
    v_exp_f32 v52, v36
    v_exp_f32 v53, v37
    v_exp_f32 v54, v38
    v_exp_f32 v55, v39
    v_mfma_f32_32x32x16_bf16 v[16:31], v[120:123], v[140:143], v[16:31]
    v_exp_f32 v56, v40
    v_exp_f32 v57, v41
    v_exp_f32 v58, v42
    v_exp_f32 v59, v43
    v_exp_f32 v60, v44
    s_mov_b32 m0, s70
    ds_read_b128 v[124:127], v236 offset:5632
    ds_read2st64_b64 v[128:131], v237 offset0:8 offset1:9
    ds_read_b128 v[116:119], v239 offset:6144
    ds_read_b128 v[120:123], v240 offset:6144
    v_exp_f32 v61, v45
    v_exp_f32 v62, v46
    v_exp_f32 v63, v47
    v_pk_fma_f32 v[48:49], v[48:49], v[228:229], v[228:229] clamp
    v_pk_fma_f32 v[50:51], v[50:51], v[228:229], v[228:229] clamp
    v_pk_fma_f32 v[52:53], v[52:53], v[228:229], v[228:229] clamp
    v_pk_fma_f32 v[54:55], v[54:55], v[228:229], v[228:229] clamp
    v_pk_fma_f32 v[56:57], v[56:57], v[228:229], v[228:229] clamp
    v_pk_fma_f32 v[58:59], v[58:59], v[228:229], v[228:229] clamp
    v_pk_fma_f32 v[60:61], v[60:61], v[228:229], v[228:229] clamp
    buffer_load_dwordx4 v204, s[48:51], 0 offen offset:0  lds
    buffer_load_dwordx4 v205, s[48:51], 0 offen offset:1024  lds
    buffer_load_dwordx4 v[180:183], v249, s[44:47], s26 offen offset:1024 sc1
    v_pk_fma_f32 v[62:63], v[62:63], v[228:229], v[228:229] clamp
    v_pk_mul_f32 v[32:33], v[32:33], v[52:53]
    v_pk_mul_f32 v[34:35], v[34:35], v[54:55]
    v_pk_fma_f32 v[32:33], v[36:37], v[48:49], v[32:33]
    v_pk_fma_f32 v[34:35], v[38:39], v[50:51], v[34:35]
    v_pk_mul_f32 v[48:49], v[48:49], v[52:53]
    v_pk_mul_f32 v[50:51], v[50:51], v[54:55]
    v_pk_mul_f32 v[40:41], v[40:41], v[60:61]
    v_pk_mul_f32 v[42:43], v[42:43], v[62:63]
    v_pk_fma_f32 v[40:41], v[44:45], v[56:57], v[40:41]
    s_cmp_le_i32 s63, 9
    v_pk_fma_f32 v[42:43], v[46:47], v[58:59], v[42:43]
    v_pk_mul_f32 v[56:57], v[56:57], v[60:61]
    v_pk_mul_f32 v[58:59], v[58:59], v[62:63]
    s_cbranch_scc1 M_evs9
M_evrs9:
    v_rcp_f32 v48, v48
    v_rcp_f32 v49, v49
    v_rcp_f32 v50, v50
    v_rcp_f32 v51, v51
    v_rcp_f32 v56, v56
    v_rcp_f32 v57, v57
    v_rcp_f32 v58, v58
    v_rcp_f32 v59, v59
    v_pk_mul_f32 v[32:33], v[32:33], v[48:49]
    v_pk_mul_f32 v[34:35], v[34:35], v[50:51]
    v_pk_fma_f32 v[32:33], v[40:41], v[56:57], v[32:33]
    v_pk_fma_f32 v[34:35], v[42:43], v[58:59], v[34:35]
    v_cvt_pk_bf16_f32 v66, v32, v33
    v_cvt_pk_bf16_f32 v67, v34, v35
    s_waitcnt vmcnt(6) lgkmcnt(0)
    v_mfma_f32_32x32x16_bf16 v[32:47], v[124:127], v[132:135], 0
    v_exp_f32 v48, v16
    v_exp_f32 v49, v17
    v_exp_f32 v50, v18
    v_exp_f32 v51, v19
    v_mfma_f32_32x32x16_bf16 v[32:47], v[116:119], v[136:139], v[32:47]
    v_exp_f32 v52, v20
    v_exp_f32 v53, v21
    v_exp_f32 v54, v22
    v_exp_f32 v55, v23
    v_mfma_f32_32x32x16_bf16 v[32:47], v[120:123], v[140:143], v[32:47]
    v_exp_f32 v56, v24
    v_exp_f32 v57, v25
    v_exp_f32 v58, v26
    v_exp_f32 v59, v27
    v_exp_f32 v60, v28
    ds_read_b128 v[124:127], v236 offset:6144
    ds_read_b64_tr_b16 v[132:133], v150
    ds_read_b64_tr_b16 v[134:135], v150 offset:2368
    ds_read_b128 v[116:119], v239 offset:0
    ds_read_b128 v[120:123], v240 offset:0
    v_exp_f32 v61, v29
    v_exp_f32 v62, v30
    v_exp_f32 v63, v31
    v_pk_fma_f32 v[48:49], v[48:49], v[228:229], v[228:229] clamp
    v_pk_fma_f32 v[50:51], v[50:51], v[228:229], v[228:229] clamp
    v_pk_fma_f32 v[52:53], v[52:53], v[228:229], v[228:229] clamp
    v_pk_fma_f32 v[54:55], v[54:55], v[228:229], v[228:229] clamp
    v_pk_fma_f32 v[56:57], v[56:57], v[228:229], v[228:229] clamp
    v_pk_fma_f32 v[58:59], v[58:59], v[228:229], v[228:229] clamp
    v_pk_fma_f32 v[60:61], v[60:61], v[228:229], v[228:229] clamp
    buffer_load_dwordx4 v206, s[48:51], 0 offen offset:2048  lds
    buffer_load_dwordx4 v207, s[48:51], 0 offen offset:3072  lds
    buffer_load_dwordx4 v[184:187], v249, s[44:47], s26 offen offset:2048 sc1
    v_pk_fma_f32 v[62:63], v[62:63], v[228:229], v[228:229] clamp
    v_pk_mul_f32 v[16:17], v[16:17], v[52:53]
    v_pk_mul_f32 v[18:19], v[18:19], v[54:55]
    v_pk_fma_f32 v[16:17], v[20:21], v[48:49], v[16:17]
    v_pk_fma_f32 v[18:19], v[22:23], v[50:51], v[18:19]
    v_pk_mul_f32 v[48:49], v[48:49], v[52:53]
    v_pk_mul_f32 v[50:51], v[50:51], v[54:55]
    v_pk_mul_f32 v[24:25], v[24:25], v[60:61]
    v_pk_mul_f32 v[26:27], v[26:27], v[62:63]
    v_pk_fma_f32 v[24:25], v[28:29], v[56:57], v[24:25]
    s_cmp_le_i32 s63, 10
    v_pk_fma_f32 v[26:27], v[30:31], v[58:59], v[26:27]
    v_pk_mul_f32 v[56:57], v[56:57], v[60:61]
    v_pk_mul_f32 v[58:59], v[58:59], v[62:63]
    s_cbranch_scc1 M_evs10
M_evrs10:
    v_mfma_f32_32x32x16_bf16 v[68:83], v[64:67], v[128:131], v[68:83]
    v_rcp_f32 v48, v48
    v_rcp_f32 v49, v49
    v_rcp_f32 v50, v50
    v_rcp_f32 v51, v51
    v_rcp_f32 v56, v56
    v_rcp_f32 v57, v57
    v_rcp_f32 v58, v58
    v_rcp_f32 v59, v59
    v_pk_mul_f32 v[16:17], v[16:17], v[48:49]
    v_pk_mul_f32 v[18:19], v[18:19], v[50:51]
    v_pk_fma_f32 v[16:17], v[24:25], v[56:57], v[16:17]
    v_pk_fma_f32 v[18:19], v[26:27], v[58:59], v[18:19]
    v_cvt_pk_bf16_f32 v64, v16, v17
    v_cvt_pk_bf16_f32 v65, v18, v19
    s_waitcnt vmcnt(7) lgkmcnt(0)
    v_mfma_f32_32x32x16_bf16 v[16:31], v[124:127], v[132:135], 0
    v_exp_f32 v48, v32
    v_exp_f32 v49, v33
    v_exp_f32 v50, v34
    v_exp_f32 v51, v35
    v_mfma_f32_32x32x16_bf16 v[16:31], v[116:119], v[136:139], v[16:31]
    v_exp_f32 v52, v36
    v_exp_f32 v53, v37
    v_exp_f32 v54, v38
    v_exp_f32 v55, v39
    v_mfma_f32_32x32x16_bf16 v[16:31], v[120:123], v[140:143], v[16:31]
    v_exp_f32 v56, v40
    v_exp_f32 v57, v41
    v_exp_f32 v58, v42
    v_exp_f32 v59, v43
    v_exp_f32 v60, v44
    s_mov_b32 m0, s66
    ds_read_b128 v[124:127], v236 offset:6656
    ds_read2st64_b64 v[128:131], v237 offset0:10 offset1:11
    ds_read_b128 v[116:119], v239 offset:2048
    ds_read_b128 v[120:123], v240 offset:2048
    v_exp_f32 v61, v45
    v_exp_f32 v62, v46
    v_exp_f32 v63, v47
    v_pk_fma_f32 v[48:49], v[48:49], v[228:229], v[228:229] clamp
    v_pk_fma_f32 v[50:51], v[50:51], v[228:229], v[228:229] clamp
    v_pk_fma_f32 v[52:53], v[52:53], v[228:229], v[228:229] clamp
    v_pk_fma_f32 v[54:55], v[54:55], v[228:229], v[228:229] clamp
    v_pk_fma_f32 v[56:57], v[56:57], v[228:229], v[228:229] clamp
    v_pk_fma_f32 v[58:59], v[58:59], v[228:229], v[228:229] clamp
    v_pk_fma_f32 v[60:61], v[60:61], v[228:229], v[228:229] clamp
    buffer_load_dwordx4 v208, s[48:51], 0 offen offset:0  lds
    buffer_load_dwordx4 v209, s[48:51], 0 offen offset:1024  lds
    buffer_load_dwordx4 v[188:191], v249, s[44:47], s26 offen offset:3072 sc1
    v_pk_fma_f32 v[62:63], v[62:63], v[228:229], v[228:229] clamp
    v_pk_mul_f32 v[32:33], v[32:33], v[52:53]
    v_pk_mul_f32 v[34:35], v[34:35], v[54:55]
    v_pk_fma_f32 v[32:33], v[36:37], v[48:49], v[32:33]
    v_pk_fma_f32 v[34:35], v[38:39], v[50:51], v[34:35]
    v_pk_mul_f32 v[48:49], v[48:49], v[52:53]
    v_pk_mul_f32 v[50:51], v[50:51], v[54:55]
    v_pk_mul_f32 v[40:41], v[40:41], v[60:61]
    v_pk_mul_f32 v[42:43], v[42:43], v[62:63]
    v_pk_fma_f32 v[40:41], v[44:45], v[56:57], v[40:41]
    s_cmp_le_i32 s63, 11
    v_pk_fma_f32 v[42:43], v[46:47], v[58:59], v[42:43]
    v_pk_mul_f32 v[56:57], v[56:57], v[60:61]
    v_pk_mul_f32 v[58:59], v[58:59], v[62:63]
    s_cbranch_scc1 M_evs11
M_evrs11:
    v_rcp_f32 v48, v48
    v_rcp_f32 v49, v49
    v_rcp_f32 v50, v50
    v_rcp_f32 v51, v51
    v_rcp_f32 v56, v56
    v_rcp_f32 v57, v57
    v_rcp_f32 v58, v58
    v_rcp_f32 v59, v59
    v_pk_mul_f32 v[32:33], v[32:33], v[48:49]
    v_pk_mul_f32 v[34:35], v[34:35], v[50:51]
    v_pk_fma_f32 v[32:33], v[40:41], v[56:57], v[32:33]
    v_pk_fma_f32 v[34:35], v[42:43], v[58:59], v[34:35]
    v_cvt_pk_bf16_f32 v66, v32, v33
    v_cvt_pk_bf16_f32 v67, v34, v35
    s_waitcnt vmcnt(7) lgkmcnt(0)
    v_mfma_f32_32x32x16_bf16 v[32:47], v[124:127], v[132:135], 0
    v_exp_f32 v48, v16
    v_exp_f32 v49, v17
    v_exp_f32 v50, v18
    v_exp_f32 v51, v19
    v_mfma_f32_32x32x16_bf16 v[32:47], v[116:119], v[136:139], v[32:47]
    v_exp_f32 v52, v20
    v_exp_f32 v53, v21
    v_exp_f32 v54, v22
    v_exp_f32 v55, v23
    v_mfma_f32_32x32x16_bf16 v[32:47], v[120:123], v[140:143], v[32:47]
    v_exp_f32 v56, v24
    v_exp_f32 v57, v25
    v_exp_f32 v58, v26
    v_exp_f32 v59, v27
    v_exp_f32 v60, v28
    ds_read_b128 v[124:127], v236 offset:7168
    ds_read_b64_tr_b16 v[132:133], v151
    ds_read_b64_tr_b16 v[134:135], v151 offset:2368
    ds_read_b128 v[116:119], v239 offset:4096
    ds_read_b128 v[120:123], v240 offset:4096
    v_exp_f32 v61, v29
    v_exp_f32 v62, v30
    v_exp_f32 v63, v31
    v_pk_fma_f32 v[48:49], v[48:49], v[228:229], v[228:229] clamp
    v_pk_fma_f32 v[50:51], v[50:51], v[228:229], v[228:229] clamp
    v_pk_fma_f32 v[52:53], v[52:53], v[228:229], v[228:229] clamp
    v_pk_fma_f32 v[54:55], v[54:55], v[228:229], v[228:229] clamp
    v_pk_fma_f32 v[56:57], v[56:57], v[228:229], v[228:229] clamp
    v_pk_fma_f32 v[58:59], v[58:59], v[228:229], v[228:229] clamp
    v_pk_fma_f32 v[60:61], v[60:61], v[228:229], v[228:229] clamp
    buffer_load_dwordx4 v210, s[48:51], 0 offen offset:2048  lds
    buffer_load_dwordx4 v211, s[48:51], 0 offen offset:3072  lds
    buffer_load_dwordx4 v[192:195], v249, s[44:47], s27 offen offset:0 sc1
    v_pk_fma_f32 v[62:63], v[62:63], v[228:229], v[228:229] clamp
    v_pk_mul_f32 v[16:17], v[16:17], v[52:53]
    v_pk_mul_f32 v[18:19], v[18:19], v[54:55]
    v_pk_fma_f32 v[16:17], v[20:21], v[48:49], v[16:17]
    v_pk_fma_f32 v[18:19], v[22:23], v[50:51], v[18:19]
    v_pk_mul_f32 v[48:49], v[48:49], v[52:53]
    v_pk_mul_f32 v[50:51], v[50:51], v[54:55]
    v_pk_mul_f32 v[24:25], v[24:25], v[60:61]
    v_pk_mul_f32 v[26:27], v[26:27], v[62:63]
    v_pk_fma_f32 v[24:25], v[28:29], v[56:57], v[24:25]
    s_cmp_le_i32 s63, 12
    v_pk_fma_f32 v[26:27], v[30:31], v[58:59], v[26:27]
    v_pk_mul_f32 v[56:57], v[56:57], v[60:61]
    v_pk_mul_f32 v[58:59], v[58:59], v[62:63]
    s_cbranch_scc1 M_evs12
M_evrs12:
    v_mfma_f32_32x32x16_bf16 v[68:83], v[64:67], v[128:131], v[68:83]
    v_rcp_f32 v48, v48
    v_rcp_f32 v49, v49
    v_rcp_f32 v50, v50
    v_rcp_f32 v51, v51
    v_rcp_f32 v56, v56
    v_rcp_f32 v57, v57
    v_rcp_f32 v58, v58
    v_rcp_f32 v59, v59
    v_pk_mul_f32 v[16:17], v[16:17], v[48:49]
    v_pk_mul_f32 v[18:19], v[18:19], v[50:51]
    v_pk_fma_f32 v[16:17], v[24:25], v[56:57], v[16:17]
    v_pk_fma_f32 v[18:19], v[26:27], v[58:59], v[18:19]
    v_cvt_pk_bf16_f32 v64, v16, v17
    v_cvt_pk_bf16_f32 v65, v18, v19
    s_waitcnt vmcnt(7) lgkmcnt(0)
    v_mfma_f32_32x32x16_bf16 v[16:31], v[124:127], v[132:135], 0
    v_exp_f32 v48, v32
    v_exp_f32 v49, v33
    v_exp_f32 v50, v34
    v_exp_f32 v51, v35
    v_mfma_f32_32x32x16_bf16 v[16:31], v[116:119], v[136:139], v[16:31]
    v_exp_f32 v52, v36
    v_exp_f32 v53, v37
    v_exp_f32 v54, v38
    v_exp_f32 v55, v39
    v_mfma_f32_32x32x16_bf16 v[16:31], v[120:123], v[140:143], v[16:31]
    v_exp_f32 v56, v40
    v_exp_f32 v57, v41
    v_exp_f32 v58, v42
    v_exp_f32 v59, v43
    v_exp_f32 v60, v44
    s_mov_b32 m0, s70
    ds_read_b128 v[124:127], v236 offset:7680
    ds_read2st64_b64 v[128:131], v237 offset0:12 offset1:13
    ds_read_b128 v[116:119], v239 offset:6144
    ds_read_b128 v[120:123], v240 offset:6144
    v_exp_f32 v61, v45
    v_exp_f32 v62, v46
    v_exp_f32 v63, v47
    v_pk_fma_f32 v[48:49], v[48:49], v[228:229], v[228:229] clamp
    v_pk_fma_f32 v[50:51], v[50:51], v[228:229], v[228:229] clamp
    v_pk_fma_f32 v[52:53], v[52:53], v[228:229], v[228:229] clamp
    v_pk_fma_f32 v[54:55], v[54:55], v[228:229], v[228:229] clamp
    v_pk_fma_f32 v[56:57], v[56:57], v[228:229], v[228:229] clamp
    v_pk_fma_f32 v[58:59], v[58:59], v[228:229], v[228:229] clamp
    v_pk_fma_f32 v[60:61], v[60:61], v[228:229], v[228:229] clamp
    buffer_load_dwordx4 v212, s[48:51], 0 offen offset:0  lds
    buffer_load_dwordx4 v213, s[48:51], 0 offen offset:1024  lds
    buffer_load_dwordx4 v[196:199], v249, s[44:47], s27 offen offset:1024 sc1
    v_pk_fma_f32 v[62:63], v[62:63], v[228:229], v[228:229] clamp
    v_pk_mul_f32 v[32:33], v[32:33], v[52:53]
    v_pk_mul_f32 v[34:35], v[34:35], v[54:55]
    v_pk_fma_f32 v[32:33], v[36:37], v[48:49], v[32:33]
    v_pk_fma_f32 v[34:35], v[38:39], v[50:51], v[34:35]
    v_pk_mul_f32 v[48:49], v[48:49], v[52:53]
    v_pk_mul_f32 v[50:51], v[50:51], v[54:55]
    v_pk_mul_f32 v[40:41], v[40:41], v[60:61]
    v_pk_mul_f32 v[42:43], v[42:43], v[62:63]
    v_pk_fma_f32 v[40:41], v[44:45], v[56:57], v[40:41]
    s_cmp_le_i32 s63, 13
    v_pk_fma_f32 v[42:43], v[46:47], v[58:59], v[42:43]
    v_pk_mul_f32 v[56:57], v[56:57], v[60:61]
    v_pk_mul_f32 v[58:59], v[58:59], v[62:63]
    s_cbranch_scc1 M_evs13
M_evrs13:
    v_rcp_f32 v48, v48
    v_rcp_f32 v49, v49
    v_rcp_f32 v50, v50
    v_rcp_f32 v51, v51
    v_rcp_f32 v56, v56
    v_rcp_f32 v57, v57
    v_rcp_f32 v58, v58
    v_rcp_f32 v59, v59
    v_pk_mul_f32 v[32:33], v[32:33], v[48:49]
    v_pk_mul_f32 v[34:35], v[34:35], v[50:51]
    v_pk_fma_f32 v[32:33], v[40:41], v[56:57], v[32:33]
    v_pk_fma_f32 v[34:35], v[42:43], v[58:59], v[34:35]
    v_cvt_pk_bf16_f32 v66, v32, v33
    v_cvt_pk_bf16_f32 v67, v34, v35
    s_waitcnt vmcnt(7) lgkmcnt(0)
    v_mfma_f32_32x32x16_bf16 v[32:47], v[124:127], v[132:135], 0
    v_exp_f32 v48, v16
    v_exp_f32 v49, v17
    v_exp_f32 v50, v18
    v_exp_f32 v51, v19
    v_mfma_f32_32x32x16_bf16 v[32:47], v[116:119], v[136:139], v[32:47]
    v_exp_f32 v52, v20
    v_exp_f32 v53, v21
    v_exp_f32 v54, v22
    v_exp_f32 v55, v23
    v_mfma_f32_32x32x16_bf16 v[32:47], v[120:123], v[140:143], v[32:47]
    v_exp_f32 v56, v24
    v_exp_f32 v57, v25
    v_exp_f32 v58, v26
    v_exp_f32 v59, v27
    v_exp_f32 v60, v28
    ds_read_b128 v[124:127], v236 offset:8192
    ds_read_b64_tr_b16 v[132:133], v152
    ds_read_b64_tr_b16 v[134:135], v152 offset:2368
    ds_read_b128 v[116:119], v239 offset:0
    ds_read_b128 v[120:123], v240 offset:0
    v_exp_f32 v61, v29
    v_exp_f32 v62, v30
    v_exp_f32 v63, v31
    v_pk_fma_f32 v[48:49], v[48:49], v[228:229], v[228:229] clamp
    v_pk_fma_f32 v[50:51], v[50:51], v[228:229], v[228:229] clamp
    v_pk_fma_f32 v[52:53], v[52:53], v[228:229], v[228:229] clamp
    v_pk_fma_f32 v[54:55], v[54:55], v[228:229], v[228:229] clamp
    v_pk_fma_f32 v[56:57], v[56:57], v[228:229], v[228:229] clamp
    v_pk_fma_f32 v[58:59], v[58:59], v[228:229], v[228:229] clamp
    v_pk_fma_f32 v[60:61], v[60:61], v[228:229], v[228:229] clamp
    buffer_load_dwordx4 v214, s[48:51], 0 offen offset:2048  lds
    buffer_load_dwordx4 v215, s[48:51], 0 offen offset:3072  lds
    buffer_load_dwordx4 v[200:203], v249, s[44:47], s27 offen offset:2048 sc1
    v_pk_fma_f32 v[62:63], v[62:63], v[228:229], v[228:229] clamp
    v_pk_mul_f32 v[16:17], v[16:17], v[52:53]
    v_pk_mul_f32 v[18:19], v[18:19], v[54:55]
    v_pk_fma_f32 v[16:17], v[20:21], v[48:49], v[16:17]
    v_pk_fma_f32 v[18:19], v[22:23], v[50:51], v[18:19]
    v_pk_mul_f32 v[48:49], v[48:49], v[52:53]
    v_pk_mul_f32 v[50:51], v[50:51], v[54:55]
    v_pk_mul_f32 v[24:25], v[24:25], v[60:61]
    v_pk_mul_f32 v[26:27], v[26:27], v[62:63]
    v_pk_fma_f32 v[24:25], v[28:29], v[56:57], v[24:25]
    s_cmp_le_i32 s63, 14
    v_pk_fma_f32 v[26:27], v[30:31], v[58:59], v[26:27]
    v_pk_mul_f32 v[56:57], v[56:57], v[60:61]
    v_pk_mul_f32 v[58:59], v[58:59], v[62:63]
    s_cbranch_scc1 M_evs14
M_evrs14:
    v_mfma_f32_32x32x16_bf16 v[68:83], v[64:67], v[128:131], v[68:83]
    v_rcp_f32 v48, v48
    v_rcp_f32 v49, v49
    v_rcp_f32 v50, v50
    v_rcp_f32 v51, v51
    v_rcp_f32 v56, v56
    v_rcp_f32 v57, v57
    v_rcp_f32 v58, v58
    v_rcp_f32 v59, v59
    v_pk_mul_f32 v[16:17], v[16:17], v[48:49]
    v_pk_mul_f32 v[18:19], v[18:19], v[50:51]
    v_pk_fma_f32 v[16:17], v[24:25], v[56:57], v[16:17]
    v_pk_fma_f32 v[18:19], v[26:27], v[58:59], v[18:19]
    v_cvt_pk_bf16_f32 v64, v16, v17
    v_cvt_pk_bf16_f32 v65, v18, v19
    s_waitcnt vmcnt(7) lgkmcnt(0)
    v_mfma_f32_32x32x16_bf16 v[16:31], v[124:127], v[132:135], 0
    v_exp_f32 v48, v32
    v_exp_f32 v49, v33
    v_exp_f32 v50, v34
    v_exp_f32 v51, v35
    v_mfma_f32_32x32x16_bf16 v[16:31], v[116:119], v[136:139], v[16:31]
    v_exp_f32 v52, v36
    v_exp_f32 v53, v37
    v_exp_f32 v54, v38
    v_exp_f32 v55, v39
    v_mfma_f32_32x32x16_bf16 v[16:31], v[120:123], v[140:143], v[16:31]
    v_exp_f32 v56, v40
    v_exp_f32 v57, v41
    v_exp_f32 v58, v42
    v_exp_f32 v59, v43
    v_exp_f32 v60, v44
    s_mov_b32 m0, s66
    ds_read_b128 v[124:127], v236 offset:8704
    ds_read2st64_b64 v[128:131], v237 offset0:14 offset1:15
    ds_read_b128 v[116:119], v239 offset:2048
    ds_read_b128 v[120:123], v240 offset:2048
    v_exp_f32 v61, v45
    v_exp_f32 v62, v46
    v_exp_f32 v63, v47
    v_pk_fma_f32 v[48:49], v[48:49], v[228:229], v[228:229] clamp
    v_pk_fma_f32 v[50:51], v[50:51], v[228:229], v[228:229] clamp
    v_pk_fma_f32 v[52:53], v[52:53], v[228:229], v[228:229] clamp
    v_pk_fma_f32 v[54:55], v[54:55], v[228:229], v[228:229] clamp
    v_pk_fma_f32 v[56:57], v[56:57], v[228:229], v[228:229] clamp
    v_pk_fma_f32 v[58:59], v[58:59], v[228:229], v[228:229] clamp
    v_pk_fma_f32 v[60:61], v[60:61], v[228:229], v[228:229] clamp
    buffer_load_dwordx4 v216, s[48:51], 0 offen offset:0  lds
    buffer_load_dwordx4 v217, s[48:51], 0 offen offset:1024  lds
    buffer_load_dwordx4 v[204:207], v249, s[44:47], s27 offen offset:3072 sc1
    v_pk_fma_f32 v[62:63], v[62:63], v[228:229], v[228:229] clamp
    v_pk_mul_f32 v[32:33], v[32:33], v[52:53]
    v_pk_mul_f32 v[34:35], v[34:35], v[54:55]
    v_pk_fma_f32 v[32:33], v[36:37], v[48:49], v[32:33]
    v_pk_fma_f32 v[34:35], v[38:39], v[50:51], v[34:35]
    v_pk_mul_f32 v[48:49], v[48:49], v[52:53]
    v_pk_mul_f32 v[50:51], v[50:51], v[54:55]
    v_pk_mul_f32 v[40:41], v[40:41], v[60:61]
    v_pk_mul_f32 v[42:43], v[42:43], v[62:63]
    v_pk_fma_f32 v[40:41], v[44:45], v[56:57], v[40:41]
    s_cmp_le_i32 s63, 15
    v_pk_fma_f32 v[42:43], v[46:47], v[58:59], v[42:43]
    v_pk_mul_f32 v[56:57], v[56:57], v[60:61]
    v_pk_mul_f32 v[58:59], v[58:59], v[62:63]
    s_cbranch_scc1 M_evs15
M_evrs15:
    v_rcp_f32 v48, v48
    v_rcp_f32 v49, v49
    v_rcp_f32 v50, v50
    v_rcp_f32 v51, v51
    v_rcp_f32 v56, v56
    v_rcp_f32 v57, v57
    v_rcp_f32 v58, v58
    v_rcp_f32 v59, v59
    v_pk_mul_f32 v[32:33], v[32:33], v[48:49]
    v_pk_mul_f32 v[34:35], v[34:35], v[50:51]
    v_pk_fma_f32 v[32:33], v[40:41], v[56:57], v[32:33]
    v_pk_fma_f32 v[34:35], v[42:43], v[58:59], v[34:35]
    v_cvt_pk_bf16_f32 v66, v32, v33
    v_cvt_pk_bf16_f32 v67, v34, v35
    s_waitcnt vmcnt(7) lgkmcnt(0)
    v_mfma_f32_32x32x16_bf16 v[32:47], v[124:127], v[132:135], 0
    v_exp_f32 v48, v16
    v_exp_f32 v49, v17
    v_exp_f32 v50, v18
    v_exp_f32 v51, v19
    v_mfma_f32_32x32x16_bf16 v[32:47], v[116:119], v[136:139], v[32:47]
    v_exp_f32 v52, v20
    v_exp_f32 v53, v21
    v_exp_f32 v54, v22
    v_exp_f32 v55, v23
    v_mfma_f32_32x32x16_bf16 v[32:47], v[120:123], v[140:143], v[32:47]
    v_exp_f32 v56, v24
    v_exp_f32 v57, v25
    v_exp_f32 v58, v26
    v_exp_f32 v59, v27
    v_exp_f32 v60, v28
    ds_read_b128 v[124:127], v236 offset:9216
    ds_read_b64_tr_b16 v[132:133], v153
    ds_read_b64_tr_b16 v[134:135], v153 offset:2368
    ds_read_b128 v[116:119], v239 offset:4096
    ds_read_b128 v[120:123], v240 offset:4096
    v_exp_f32 v61, v29
    v_exp_f32 v62, v30
    v_exp_f32 v63, v31
    v_pk_fma_f32 v[48:49], v[48:49], v[228:229], v[228:229] clamp
    v_pk_fma_f32 v[50:51], v[50:51], v[228:229], v[228:229] clamp
    v_pk_fma_f32 v[52:53], v[52:53], v[228:229], v[228:229] clamp
    v_pk_fma_f32 v[54:55], v[54:55], v[228:229], v[228:229] clamp
    v_pk_fma_f32 v[56:57], v[56:57], v[228:229], v[228:229] clamp
    v_pk_fma_f32 v[58:59], v[58:59], v[228:229], v[228:229] clamp
    v_pk_fma_f32 v[60:61], v[60:61], v[228:229], v[228:229] clamp
    buffer_load_dwordx4 v218, s[48:51], 0 offen offset:2048  lds
    buffer_load_dwordx4 v219, s[48:51], 0 offen offset:3072  lds
    v_pk_fma_f32 v[62:63], v[62:63], v[228:229], v[228:229] clamp
    v_pk_mul_f32 v[16:17], v[16:17], v[52:53]
    v_pk_mul_f32 v[18:19], v[18:19], v[54:55]
    v_pk_fma_f32 v[16:17], v[20:21], v[48:49], v[16:17]
    v_pk_fma_f32 v[18:19], v[22:23], v[50:51], v[18:19]
    v_pk_mul_f32 v[48:49], v[48:49], v[52:53]
    v_pk_mul_f32 v[50:51], v[50:51], v[54:55]
    v_pk_mul_f32 v[24:25], v[24:25], v[60:61]
    v_pk_mul_f32 v[26:27], v[26:27], v[62:63]
    v_pk_fma_f32 v[24:25], v[28:29], v[56:57], v[24:25]
    s_cmp_le_i32 s63, 16
    v_pk_fma_f32 v[26:27], v[30:31], v[58:59], v[26:27]
    v_pk_mul_f32 v[56:57], v[56:57], v[60:61]
    v_pk_mul_f32 v[58:59], v[58:59], v[62:63]
    s_cbranch_scc1 M_evs16
M_evrs16:
    v_mfma_f32_32x32x16_bf16 v[68:83], v[64:67], v[128:131], v[68:83]
    v_rcp_f32 v48, v48
    v_rcp_f32 v49, v49
    v_rcp_f32 v50, v50
    v_rcp_f32 v51, v51
    v_rcp_f32 v56, v56
    v_rcp_f32 v57, v57
    v_rcp_f32 v58, v58
    v_rcp_f32 v59, v59
    v_pk_mul_f32 v[16:17], v[16:17], v[48:49]
    v_pk_mul_f32 v[18:19], v[18:19], v[50:51]
    v_pk_fma_f32 v[16:17], v[24:25], v[56:57], v[16:17]
    v_pk_fma_f32 v[18:19], v[26:27], v[58:59], v[18:19]
    v_cvt_pk_bf16_f32 v64, v16, v17
    v_cvt_pk_bf16_f32 v65, v18, v19
    s_waitcnt vmcnt(6) lgkmcnt(0)
    v_mfma_f32_32x32x16_bf16 v[16:31], v[124:127], v[132:135], 0
    v_exp_f32 v48, v32
    v_exp_f32 v49, v33
    v_exp_f32 v50, v34
    v_exp_f32 v51, v35
    v_mfma_f32_32x32x16_bf16 v[16:31], v[116:119], v[136:139], v[16:31]
    v_exp_f32 v52, v36
    v_exp_f32 v53, v37
    v_exp_f32 v54, v38
    v_exp_f32 v55, v39
    v_mfma_f32_32x32x16_bf16 v[16:31], v[120:123], v[140:143], v[16:31]
    v_exp_f32 v56, v40
    v_exp_f32 v57, v41
    v_exp_f32 v58, v42
    v_exp_f32 v59, v43
    v_exp_f32 v60, v44
    s_mov_b32 m0, s70
    ds_read_b128 v[124:127], v236 offset:9728
    ds_read2st64_b64 v[128:131], v237 offset0:16 offset1:17
    ds_read_b128 v[116:119], v239 offset:6144
    ds_read_b128 v[120:123], v240 offset:6144
    v_exp_f32 v61, v45
    v_exp_f32 v62, v46
    v_exp_f32 v63, v47
    v_pk_fma_f32 v[48:49], v[48:49], v[228:229], v[228:229] clamp
    v_pk_fma_f32 v[50:51], v[50:51], v[228:229], v[228:229] clamp
    v_pk_fma_f32 v[52:53], v[52:53], v[228:229], v[228:229] clamp
    v_pk_fma_f32 v[54:55], v[54:55], v[228:229], v[228:229] clamp
    v_pk_fma_f32 v[56:57], v[56:57], v[228:229], v[228:229] clamp
    v_pk_fma_f32 v[58:59], v[58:59], v[228:229], v[228:229] clamp
    v_pk_fma_f32 v[60:61], v[60:61], v[228:229], v[228:229] clamp
    buffer_load_dwordx4 v220, s[48:51], 0 offen offset:0  lds
    buffer_load_dwordx4 v221, s[48:51], 0 offen offset:1024  lds
    v_pk_fma_f32 v[62:63], v[62:63], v[228:229], v[228:229] clamp
    v_pk_mul_f32 v[32:33], v[32:33], v[52:53]
    v_pk_mul_f32 v[34:35], v[34:35], v[54:55]
    v_pk_fma_f32 v[32:33], v[36:37], v[48:49], v[32:33]
    v_pk_fma_f32 v[34:35], v[38:39], v[50:51], v[34:35]
    v_pk_mul_f32 v[48:49], v[48:49], v[52:53]
    v_pk_mul_f32 v[50:51], v[50:51], v[54:55]
    v_pk_mul_f32 v[40:41], v[40:41], v[60:61]
    v_pk_mul_f32 v[42:43], v[42:43], v[62:63]
    v_pk_fma_f32 v[40:41], v[44:45], v[56:57], v[40:41]
    s_cmp_le_i32 s63, 17
    v_pk_fma_f32 v[42:43], v[46:47], v[58:59], v[42:43]
    v_pk_mul_f32 v[56:57], v[56:57], v[60:61]
    v_pk_mul_f32 v[58:59], v[58:59], v[62:63]
    s_cbranch_scc1 M_evs17
M_evrs17:
    v_rcp_f32 v48, v48
    v_rcp_f32 v49, v49
    v_rcp_f32 v50, v50
    v_rcp_f32 v51, v51
    v_rcp_f32 v56, v56
    v_rcp_f32 v57, v57
    v_rcp_f32 v58, v58
    v_rcp_f32 v59, v59
    v_pk_mul_f32 v[32:33], v[32:33], v[48:49]
    v_pk_mul_f32 v[34:35], v[34:35], v[50:51]
    v_pk_fma_f32 v[32:33], v[40:41], v[56:57], v[32:33]
    v_pk_fma_f32 v[34:35], v[42:43], v[58:59], v[34:35]
    v_cvt_pk_bf16_f32 v66, v32, v33
    v_cvt_pk_bf16_f32 v67, v34, v35
    s_waitcnt vmcnt(5) lgkmcnt(0)
    v_mfma_f32_32x32x16_bf16 v[32:47], v[124:127], v[132:135], 0
    v_exp_f32 v48, v16
    v_exp_f32 v49, v17
    v_exp_f32 v50, v18
    v_exp_f32 v51, v19
    v_mfma_f32_32x32x16_bf16 v[32:47], v[116:119], v[136:139], v[32:47]
    v_exp_f32 v52, v20
    v_exp_f32 v53, v21
    v_exp_f32 v54, v22
    v_exp_f32 v55, v23
    v_mfma_f32_32x32x16_bf16 v[32:47], v[120:123], v[140:143], v[32:47]
    v_exp_f32 v56, v24
    v_exp_f32 v57, v25
    v_exp_f32 v58, v26
    v_exp_f32 v59, v27
    v_exp_f32 v60, v28
    ds_read_b128 v[124:127], v236 offset:10240
    ds_read_b64_tr_b16 v[132:133], v154
    ds_read_b64_tr_b16 v[134:135], v154 offset:2368
    ds_read_b128 v[116:119], v239 offset:0
    ds_read_b128 v[120:123], v240 offset:0
    v_exp_f32 v61, v29
    v_exp_f32 v62, v30
    v_exp_f32 v63, v31
    v_pk_fma_f32 v[48:49], v[48:49], v[228:229], v[228:229] clamp
    v_pk_fma_f32 v[50:51], v[50:51], v[228:229], v[228:229] clamp
    v_pk_fma_f32 v[52:53], v[52:53], v[228:229], v[228:229] clamp
    v_pk_fma_f32 v[54:55], v[54:55], v[228:229], v[228:229] clamp
    v_pk_fma_f32 v[56:57], v[56:57], v[228:229], v[228:229] clamp
    v_pk_fma_f32 v[58:59], v[58:59], v[228:229], v[228:229] clamp
    v_pk_fma_f32 v[60:61], v[60:61], v[228:229], v[228:229] clamp
    buffer_load_dwordx4 v222, s[48:51], 0 offen offset:2048  lds
    buffer_load_dwordx4 v223, s[48:51], 0 offen offset:3072  lds
    v_pk_fma_f32 v[62:63], v[62:63], v[228:229], v[228:229] clamp
    v_pk_mul_f32 v[16:17], v[16:17], v[52:53]
    v_pk_mul_f32 v[18:19], v[18:19], v[54:55]
    v_pk_fma_f32 v[16:17], v[20:21], v[48:49], v[16:17]
    v_pk_fma_f32 v[18:19], v[22:23], v[50:51], v[18:19]
    v_pk_mul_f32 v[48:49], v[48:49], v[52:53]
    v_pk_mul_f32 v[50:51], v[50:51], v[54:55]
    v_pk_mul_f32 v[24:25], v[24:25], v[60:61]
    v_pk_mul_f32 v[26:27], v[26:27], v[62:63]
    v_pk_fma_f32 v[24:25], v[28:29], v[56:57], v[24:25]
    s_cmp_le_i32 s63, 18
    v_pk_fma_f32 v[26:27], v[30:31], v[58:59], v[26:27]
    v_pk_mul_f32 v[56:57], v[56:57], v[60:61]
    v_pk_mul_f32 v[58:59], v[58:59], v[62:63]
    s_cbranch_scc1 M_evs18
M_evrs18:
    v_mfma_f32_32x32x16_bf16 v[68:83], v[64:67], v[128:131], v[68:83]
    v_rcp_f32 v48, v48
    v_rcp_f32 v49, v49
    v_rcp_f32 v50, v50
    v_rcp_f32 v51, v51
    v_rcp_f32 v56, v56
    v_rcp_f32 v57, v57
    v_rcp_f32 v58, v58
    v_rcp_f32 v59, v59
    v_pk_mul_f32 v[16:17], v[16:17], v[48:49]
    v_pk_mul_f32 v[18:19], v[18:19], v[50:51]
    v_pk_fma_f32 v[16:17], v[24:25], v[56:57], v[16:17]
    v_pk_fma_f32 v[18:19], v[26:27], v[58:59], v[18:19]
    v_cvt_pk_bf16_f32 v64, v16, v17
    v_cvt_pk_bf16_f32 v65, v18, v19
    s_waitcnt vmcnt(4) lgkmcnt(0)
    v_mfma_f32_32x32x16_bf16 v[16:31], v[124:127], v[132:135], 0
    v_exp_f32 v48, v32
    v_exp_f32 v49, v33
    v_exp_f32 v50, v34
    v_exp_f32 v51, v35
    v_mfma_f32_32x32x16_bf16 v[16:31], v[116:119], v[136:139], v[16:31]
    v_exp_f32 v52, v36
    v_exp_f32 v53, v37
    v_exp_f32 v54, v38
    v_exp_f32 v55, v39
    v_mfma_f32_32x32x16_bf16 v[16:31], v[120:123], v[140:143], v[16:31]
    v_exp_f32 v56, v40
    v_exp_f32 v57, v41
    v_exp_f32 v58, v42
    v_exp_f32 v59, v43
    v_exp_f32 v60, v44
    s_mov_b32 m0, s66
    ds_read_b128 v[124:127], v236 offset:10752
    ds_read2st64_b64 v[128:131], v237 offset0:18 offset1:19
    ds_read_b128 v[116:119], v239 offset:2048
    ds_read_b128 v[120:123], v240 offset:2048
    v_exp_f32 v61, v45
    v_exp_f32 v62, v46
    v_exp_f32 v63, v47
    v_pk_fma_f32 v[48:49], v[48:49], v[228:229], v[228:229] clamp
    v_pk_fma_f32 v[50:51], v[50:51], v[228:229], v[228:229] clamp
    v_pk_fma_f32 v[52:53], v[52:53], v[228:229], v[228:229] clamp
    v_pk_fma_f32 v[54:55], v[54:55], v[228:229], v[228:229] clamp
    v_pk_fma_f32 v[56:57], v[56:57], v[228:229], v[228:229] clamp
    v_pk_fma_f32 v[58:59], v[58:59], v[228:229], v[228:229] clamp
    v_pk_fma_f32 v[60:61], v[60:61], v[228:229], v[228:229] clamp
    buffer_load_dwordx4 v224, s[48:51], 0 offen offset:0  lds
    buffer_load_dwordx4 v225, s[48:51], 0 offen offset:1024  lds
    v_pk_fma_f32 v[62:63], v[62:63], v[228:229], v[228:229] clamp
    v_pk_mul_f32 v[32:33], v[32:33], v[52:53]
    v_pk_mul_f32 v[34:35], v[34:35], v[54:55]
    v_pk_fma_f32 v[32:33], v[36:37], v[48:49], v[32:33]
    v_pk_fma_f32 v[34:35], v[38:39], v[50:51], v[34:35]
    v_pk_mul_f32 v[48:49], v[48:49], v[52:53]
    v_pk_mul_f32 v[50:51], v[50:51], v[54:55]
    v_pk_mul_f32 v[40:41], v[40:41], v[60:61]
    v_pk_mul_f32 v[42:43], v[42:43], v[62:63]
    v_pk_fma_f32 v[40:41], v[44:45], v[56:57], v[40:41]
    s_cmp_le_i32 s63, 19
    v_pk_fma_f32 v[42:43], v[46:47], v[58:59], v[42:43]
    v_pk_mul_f32 v[56:57], v[56:57], v[60:61]
    v_pk_mul_f32 v[58:59], v[58:59], v[62:63]
    s_cbranch_scc1 M_evs19
M_evrs19:
    v_rcp_f32 v48, v48
    v_rcp_f32 v49, v49
    v_rcp_f32 v50, v50
    v_rcp_f32 v51, v51
    v_rcp_f32 v56, v56
    v_rcp_f32 v57, v57
    v_rcp_f32 v58, v58
    v_rcp_f32 v59, v59
    v_pk_mul_f32 v[32:33], v[32:33], v[48:49]
    v_pk_mul_f32 v[34:35], v[34:35], v[50:51]
    v_pk_fma_f32 v[32:33], v[40:41], v[56:57], v[32:33]
    v_pk_fma_f32 v[34:35], v[42:43], v[58:59], v[34:35]
    v_cvt_pk_bf16_f32 v66, v32, v33
    v_cvt_pk_bf16_f32 v67, v34, v35
    s_waitcnt vmcnt(4) lgkmcnt(0)
    v_mfma_f32_32x32x16_bf16 v[32:47], v[124:127], v[132:135], 0
    v_exp_f32 v48, v16
    v_exp_f32 v49, v17
    v_exp_f32 v50, v18
    v_exp_f32 v51, v19
    v_mfma_f32_32x32x16_bf16 v[32:47], v[116:119], v[136:139], v[32:47]
    v_exp_f32 v52, v20
    v_exp_f32 v53, v21
    v_exp_f32 v54, v22
    v_exp_f32 v55, v23
    v_mfma_f32_32x32x16_bf16 v[32:47], v[120:123], v[140:143], v[32:47]
    v_exp_f32 v56, v24
    v_exp_f32 v57, v25
    v_exp_f32 v58, v26
    v_exp_f32 v59, v27
    v_exp_f32 v60, v28
    ds_read_b128 v[124:127], v236 offset:11264
    ds_read_b64_tr_b16 v[132:133], v155
    ds_read_b64_tr_b16 v[134:135], v155 offset:2368
    ds_read_b128 v[116:119], v239 offset:4096
    ds_read_b128 v[120:123], v240 offset:4096
    v_exp_f32 v61, v29
    v_exp_f32 v62, v30
    v_exp_f32 v63, v31
    v_pk_fma_f32 v[48:49], v[48:49], v[228:229], v[228:229] clamp
    v_pk_fma_f32 v[50:51], v[50:51], v[228:229], v[228:229] clamp
    v_pk_fma_f32 v[52:53], v[52:53], v[228:229], v[228:229] clamp
    v_pk_fma_f32 v[54:55], v[54:55], v[228:229], v[228:229] clamp
    v_pk_fma_f32 v[56:57], v[56:57], v[228:229], v[228:229] clamp
    v_pk_fma_f32 v[58:59], v[58:59], v[228:229], v[228:229] clamp
    v_pk_fma_f32 v[60:61], v[60:61], v[228:229], v[228:229] clamp
    buffer_load_dwordx4 v226, s[48:51], 0 offen offset:2048  lds
    buffer_load_dwordx4 v227, s[48:51], 0 offen offset:3072  lds
    v_pk_fma_f32 v[62:63], v[62:63], v[228:229], v[228:229] clamp
    v_pk_mul_f32 v[16:17], v[16:17], v[52:53]
    v_pk_mul_f32 v[18:19], v[18:19], v[54:55]
    v_pk_fma_f32 v[16:17], v[20:21], v[48:49], v[16:17]
    v_pk_fma_f32 v[18:19], v[22:23], v[50:51], v[18:19]
    v_pk_mul_f32 v[48:49], v[48:49], v[52:53]
    v_pk_mul_f32 v[50:51], v[50:51], v[54:55]
    v_pk_mul_f32 v[24:25], v[24:25], v[60:61]
    v_pk_mul_f32 v[26:27], v[26:27], v[62:63]
    v_pk_fma_f32 v[24:25], v[28:29], v[56:57], v[24:25]
    s_cmp_le_i32 s63, 20
    v_pk_fma_f32 v[26:27], v[30:31], v[58:59], v[26:27]
    v_pk_mul_f32 v[56:57], v[56:57], v[60:61]
    v_pk_mul_f32 v[58:59], v[58:59], v[62:63]
    s_cbranch_scc1 M_evs20
M_evrs20:
    v_mfma_f32_32x32x16_bf16 v[68:83], v[64:67], v[128:131], v[68:83]
    v_rcp_f32 v48, v48
    v_rcp_f32 v49, v49
    v_rcp_f32 v50, v50
    v_rcp_f32 v51, v51
    v_rcp_f32 v56, v56
    v_rcp_f32 v57, v57
    v_rcp_f32 v58, v58
    v_rcp_f32 v59, v59
    v_pk_mul_f32 v[16:17], v[16:17], v[48:49]
    v_pk_mul_f32 v[18:19], v[18:19], v[50:51]
    v_pk_fma_f32 v[16:17], v[24:25], v[56:57], v[16:17]
    v_pk_fma_f32 v[18:19], v[26:27], v[58:59], v[18:19]
    v_cvt_pk_bf16_f32 v64, v16, v17
    v_cvt_pk_bf16_f32 v65, v18, v19
    s_waitcnt vmcnt(4) lgkmcnt(0)
    v_mfma_f32_32x32x16_bf16 v[16:31], v[124:127], v[132:135], 0
    v_exp_f32 v48, v32
    v_exp_f32 v49, v33
    v_exp_f32 v50, v34
    v_exp_f32 v51, v35
    v_mfma_f32_32x32x16_bf16 v[16:31], v[116:119], v[136:139], v[16:31]
    v_exp_f32 v52, v36
    v_exp_f32 v53, v37
    v_exp_f32 v54, v38
    v_exp_f32 v55, v39
    v_mfma_f32_32x32x16_bf16 v[16:31], v[120:123], v[140:143], v[16:31]
    v_exp_f32 v56, v40
    v_exp_f32 v57, v41
    v_exp_f32 v58, v42
    v_exp_f32 v59, v43
    v_exp_f32 v60, v44
    s_mov_b32 m0, s70
    ds_read_b128 v[124:127], v236 offset:11776
    ds_read2st64_b64 v[128:131], v237 offset0:20 offset1:21
    ds_read_b128 v[116:119], v239 offset:6144
    ds_read_b128 v[120:123], v240 offset:6144
    v_exp_f32 v61, v45
    v_exp_f32 v62, v46
    v_exp_f32 v63, v47
    v_pk_fma_f32 v[48:49], v[48:49], v[228:229], v[228:229] clamp
    v_pk_fma_f32 v[50:51], v[50:51], v[228:229], v[228:229] clamp
    v_pk_fma_f32 v[52:53], v[52:53], v[228:229], v[228:229] clamp
    v_pk_fma_f32 v[54:55], v[54:55], v[228:229], v[228:229] clamp
    v_pk_fma_f32 v[56:57], v[56:57], v[228:229], v[228:229] clamp
    v_pk_fma_f32 v[58:59], v[58:59], v[228:229], v[228:229] clamp
    v_pk_fma_f32 v[60:61], v[60:61], v[228:229], v[228:229] clamp
    buffer_load_dwordx4 v247, s[48:51], 0 offen offset:0  lds
    buffer_load_dwordx4 v247, s[48:51], 0 offen offset:1024  lds
    v_pk_fma_f32 v[62:63], v[62:63], v[228:229], v[228:229] clamp
    v_pk_mul_f32 v[32:33], v[32:33], v[52:53]
    v_pk_mul_f32 v[34:35], v[34:35], v[54:55]
    v_pk_fma_f32 v[32:33], v[36:37], v[48:49], v[32:33]
    v_pk_fma_f32 v[34:35], v[38:39], v[50:51], v[34:35]
    v_pk_mul_f32 v[48:49], v[48:49], v[52:53]
    v_pk_mul_f32 v[50:51], v[50:51], v[54:55]
    v_pk_mul_f32 v[40:41], v[40:41], v[60:61]
    v_pk_mul_f32 v[42:43], v[42:43], v[62:63]
    v_pk_fma_f32 v[40:41], v[44:45], v[56:57], v[40:41]
    s_cmp_le_i32 s63, 21
    v_pk_fma_f32 v[42:43], v[46:47], v[58:59], v[42:43]
    v_pk_mul_f32 v[56:57], v[56:57], v[60:61]
    v_pk_mul_f32 v[58:59], v[58:59], v[62:63]
    s_cbranch_scc1 M_evs21
M_evrs21:
    v_rcp_f32 v48, v48
    v_rcp_f32 v49, v49
    v_rcp_f32 v50, v50
    v_rcp_f32 v51, v51
    v_rcp_f32 v56, v56
    v_rcp_f32 v57, v57
    v_rcp_f32 v58, v58
    v_rcp_f32 v59, v59
    v_pk_mul_f32 v[32:33], v[32:33], v[48:49]
    v_pk_mul_f32 v[34:35], v[34:35], v[50:51]
    v_pk_fma_f32 v[32:33], v[40:41], v[56:57], v[32:33]
    v_pk_fma_f32 v[34:35], v[42:43], v[58:59], v[34:35]
    v_cvt_pk_bf16_f32 v66, v32, v33
    v_cvt_pk_bf16_f32 v67, v34, v35
    s_waitcnt vmcnt(4) lgkmcnt(0)
    v_mfma_f32_32x32x16_bf16 v[32:47], v[124:127], v[132:135], 0
    v_exp_f32 v48, v16
    v_exp_f32 v49, v17
    v_exp_f32 v50, v18
    v_exp_f32 v51, v19
    v_mfma_f32_32x32x16_bf16 v[32:47], v[116:119], v[136:139], v[32:47]
    v_exp_f32 v52, v20
    v_exp_f32 v53, v21
    v_exp_f32 v54, v22
    v_exp_f32 v55, v23
    v_mfma_f32_32x32x16_bf16 v[32:47], v[120:123], v[140:143], v[32:47]
    v_exp_f32 v56, v24
    v_exp_f32 v57, v25
    v_exp_f32 v58, v26
    v_exp_f32 v59, v27
    v_exp_f32 v60, v28
    ds_read_b128 v[124:127], v236 offset:12288
    ds_read_b64_tr_b16 v[132:133], v156
    ds_read_b64_tr_b16 v[134:135], v156 offset:2368
    ds_read_b128 v[116:119], v239 offset:0
    ds_read_b128 v[120:123], v240 offset:0
    v_exp_f32 v61, v29
    v_exp_f32 v62, v30
    v_exp_f32 v63, v31
    v_pk_fma_f32 v[48:49], v[48:49], v[228:229], v[228:229] clamp
    v_pk_fma_f32 v[50:51], v[50:51], v[228:229], v[228:229] clamp
    v_pk_fma_f32 v[52:53], v[52:53], v[228:229], v[228:229] clamp
    v_pk_fma_f32 v[54:55], v[54:55], v[228:229], v[228:229] clamp
    v_pk_fma_f32 v[56:57], v[56:57], v[228:229], v[228:229] clamp
    v_pk_fma_f32 v[58:59], v[58:59], v[228:229], v[228:229] clamp
    v_pk_fma_f32 v[60:61], v[60:61], v[228:229], v[228:229] clamp
    buffer_load_dwordx4 v247, s[48:51], 0 offen offset:2048  lds
    buffer_load_dwordx4 v247, s[48:51], 0 offen offset:3072  lds
    v_pk_fma_f32 v[62:63], v[62:63], v[228:229], v[228:229] clamp
    v_pk_mul_f32 v[16:17], v[16:17], v[52:53]
    v_pk_mul_f32 v[18:19], v[18:19], v[54:55]
    v_pk_fma_f32 v[16:17], v[20:21], v[48:49], v[16:17]
    v_pk_fma_f32 v[18:19], v[22:23], v[50:51], v[18:19]
    v_pk_mul_f32 v[48:49], v[48:49], v[52:53]
    v_pk_mul_f32 v[50:51], v[50:51], v[54:55]
    v_pk_mul_f32 v[24:25], v[24:25], v[60:61]
    v_pk_mul_f32 v[26:27], v[26:27], v[62:63]
    v_pk_fma_f32 v[24:25], v[28:29], v[56:57], v[24:25]
    s_cmp_le_i32 s63, 22
    v_pk_fma_f32 v[26:27], v[30:31], v[58:59], v[26:27]
    v_pk_mul_f32 v[56:57], v[56:57], v[60:61]
    v_pk_mul_f32 v[58:59], v[58:59], v[62:63]
    s_cbranch_scc1 M_evs22
M_evrs22:
    v_mfma_f32_32x32x16_bf16 v[68:83], v[64:67], v[128:131], v[68:83]
    v_rcp_f32 v48, v48
    v_rcp_f32 v49, v49
    v_rcp_f32 v50, v50
    v_rcp_f32 v51, v51
    v_rcp_f32 v56, v56
    v_rcp_f32 v57, v57
    v_rcp_f32 v58, v58
    v_rcp_f32 v59, v59
    v_pk_mul_f32 v[16:17], v[16:17], v[48:49]
    v_pk_mul_f32 v[18:19], v[18:19], v[50:51]
    v_pk_fma_f32 v[16:17], v[24:25], v[56:57], v[16:17]
    v_pk_fma_f32 v[18:19], v[26:27], v[58:59], v[18:19]
    v_cvt_pk_bf16_f32 v64, v16, v17
    v_cvt_pk_bf16_f32 v65, v18, v19
    s_waitcnt vmcnt(4) lgkmcnt(0)
    v_mfma_f32_32x32x16_bf16 v[16:31], v[124:127], v[132:135], 0
    v_exp_f32 v48, v32
    v_exp_f32 v49, v33
    v_exp_f32 v50, v34
    v_exp_f32 v51, v35
    v_mfma_f32_32x32x16_bf16 v[16:31], v[116:119], v[136:139], v[16:31]
    v_exp_f32 v52, v36
    v_exp_f32 v53, v37
    v_exp_f32 v54, v38
    v_exp_f32 v55, v39
    v_mfma_f32_32x32x16_bf16 v[16:31], v[120:123], v[140:143], v[16:31]
    v_exp_f32 v56, v40
    v_exp_f32 v57, v41
    v_exp_f32 v58, v42
    v_exp_f32 v59, v43
    v_exp_f32 v60, v44
    s_mov_b32 m0, s66
    ds_read_b128 v[124:127], v236 offset:12800
    ds_read2st64_b64 v[128:131], v237 offset0:22 offset1:23
    ds_read_b128 v[116:119], v239 offset:2048
    ds_read_b128 v[120:123], v240 offset:2048
    v_exp_f32 v61, v45
    v_exp_f32 v62, v46
    v_exp_f32 v63, v47
    v_pk_fma_f32 v[48:49], v[48:49], v[228:229], v[228:229] clamp
    v_pk_fma_f32 v[50:51], v[50:51], v[228:229], v[228:229] clamp
    v_pk_fma_f32 v[52:53], v[52:53], v[228:229], v[228:229] clamp
    v_pk_fma_f32 v[54:55], v[54:55], v[228:229], v[228:229] clamp
    v_pk_fma_f32 v[56:57], v[56:57], v[228:229], v[228:229] clamp
    v_pk_fma_f32 v[58:59], v[58:59], v[228:229], v[228:229] clamp
    v_pk_fma_f32 v[60:61], v[60:61], v[228:229], v[228:229] clamp
    buffer_load_dwordx4 v247, s[48:51], 0 offen offset:0  lds
    buffer_load_dwordx4 v247, s[48:51], 0 offen offset:1024  lds
    v_pk_fma_f32 v[62:63], v[62:63], v[228:229], v[228:229] clamp
    v_pk_mul_f32 v[32:33], v[32:33], v[52:53]
    v_pk_mul_f32 v[34:35], v[34:35], v[54:55]
    v_pk_fma_f32 v[32:33], v[36:37], v[48:49], v[32:33]
    v_pk_fma_f32 v[34:35], v[38:39], v[50:51], v[34:35]
    v_pk_mul_f32 v[48:49], v[48:49], v[52:53]
    v_pk_mul_f32 v[50:51], v[50:51], v[54:55]
    v_pk_mul_f32 v[40:41], v[40:41], v[60:61]
    v_pk_mul_f32 v[42:43], v[42:43], v[62:63]
    v_pk_fma_f32 v[40:41], v[44:45], v[56:57], v[40:41]
    s_cmp_le_i32 s63, 23
    v_pk_fma_f32 v[42:43], v[46:47], v[58:59], v[42:43]
    v_pk_mul_f32 v[56:57], v[56:57], v[60:61]
    v_pk_mul_f32 v[58:59], v[58:59], v[62:63]
    s_cbranch_scc1 M_evs23
M_evrs23:
    v_rcp_f32 v48, v48
    v_rcp_f32 v49, v49
    v_rcp_f32 v50, v50
    v_rcp_f32 v51, v51
    v_rcp_f32 v56, v56
    v_rcp_f32 v57, v57
    v_rcp_f32 v58, v58
    v_rcp_f32 v59, v59
    v_pk_mul_f32 v[32:33], v[32:33], v[48:49]
    v_pk_mul_f32 v[34:35], v[34:35], v[50:51]
    v_pk_fma_f32 v[32:33], v[40:41], v[56:57], v[32:33]
    v_pk_fma_f32 v[34:35], v[42:43], v[58:59], v[34:35]
    v_cvt_pk_bf16_f32 v66, v32, v33
    v_cvt_pk_bf16_f32 v67, v34, v35
    s_waitcnt vmcnt(4) lgkmcnt(0)
    v_mfma_f32_32x32x16_bf16 v[32:47], v[124:127], v[132:135], 0
    v_exp_f32 v48, v16
    v_exp_f32 v49, v17
    v_exp_f32 v50, v18
    v_exp_f32 v51, v19
    v_mfma_f32_32x32x16_bf16 v[32:47], v[116:119], v[136:139], v[32:47]
    v_exp_f32 v52, v20
    v_exp_f32 v53, v21
    v_exp_f32 v54, v22
    v_exp_f32 v55, v23
    v_mfma_f32_32x32x16_bf16 v[32:47], v[120:123], v[140:143], v[32:47]
    v_exp_f32 v56, v24
    v_exp_f32 v57, v25
    v_exp_f32 v58, v26
    v_exp_f32 v59, v27
    v_exp_f32 v60, v28
    ds_read_b128 v[124:127], v236 offset:13312
    ds_read_b64_tr_b16 v[132:133], v156
    ds_read_b64_tr_b16 v[134:135], v156 offset:2368
    ds_read_b128 v[116:119], v239 offset:4096
    ds_read_b128 v[120:123], v240 offset:4096
    v_exp_f32 v61, v29
    v_exp_f32 v62, v30
    v_exp_f32 v63, v31
    v_pk_fma_f32 v[48:49], v[48:49], v[228:229], v[228:229] clamp
    v_pk_fma_f32 v[50:51], v[50:51], v[228:229], v[228:229] clamp
    v_pk_fma_f32 v[52:53], v[52:53], v[228:229], v[228:229] clamp
    v_pk_fma_f32 v[54:55], v[54:55], v[228:229], v[228:229] clamp
    v_pk_fma_f32 v[56:57], v[56:57], v[228:229], v[228:229] clamp
    v_pk_fma_f32 v[58:59], v[58:59], v[228:229], v[228:229] clamp
    v_pk_fma_f32 v[60:61], v[60:61], v[228:229], v[228:229] clamp
    buffer_load_dwordx4 v247, s[48:51], 0 offen offset:2048  lds
    buffer_load_dwordx4 v247, s[48:51], 0 offen offset:3072  lds
    v_pk_fma_f32 v[62:63], v[62:63], v[228:229], v[228:229] clamp
    v_pk_mul_f32 v[16:17], v[16:17], v[52:53]
    v_pk_mul_f32 v[18:19], v[18:19], v[54:55]
    v_pk_fma_f32 v[16:17], v[20:21], v[48:49], v[16:17]
    v_pk_fma_f32 v[18:19], v[22:23], v[50:51], v[18:19]
    v_pk_mul_f32 v[48:49], v[48:49], v[52:53]
    v_pk_mul_f32 v[50:51], v[50:51], v[54:55]
    v_pk_mul_f32 v[24:25], v[24:25], v[60:61]
    v_pk_mul_f32 v[26:27], v[26:27], v[62:63]
    v_pk_fma_f32 v[24:25], v[28:29], v[56:57], v[24:25]
    s_cmp_le_i32 s63, 24
    v_pk_fma_f32 v[26:27], v[30:31], v[58:59], v[26:27]
    v_pk_mul_f32 v[56:57], v[56:57], v[60:61]
    v_pk_mul_f32 v[58:59], v[58:59], v[62:63]
    s_cbranch_scc1 M_evs24
M_evrs24:
    v_mfma_f32_32x32x16_bf16 v[68:83], v[64:67], v[128:131], v[68:83]
    v_rcp_f32 v48, v48
    v_rcp_f32 v49, v49
    v_rcp_f32 v50, v50
    v_rcp_f32 v51, v51
    v_rcp_f32 v56, v56
    v_rcp_f32 v57, v57
    v_rcp_f32 v58, v58
    v_rcp_f32 v59, v59
    v_pk_mul_f32 v[16:17], v[16:17], v[48:49]
    v_pk_mul_f32 v[18:19], v[18:19], v[50:51]
    v_pk_fma_f32 v[16:17], v[24:25], v[56:57], v[16:17]
    v_pk_fma_f32 v[18:19], v[26:27], v[58:59], v[18:19]
    v_cvt_pk_bf16_f32 v64, v16, v17
    v_cvt_pk_bf16_f32 v65, v18, v19
    s_waitcnt vmcnt(4) lgkmcnt(0)
    v_mfma_f32_32x32x16_bf16 v[16:31], v[124:127], v[132:135], 0
    v_exp_f32 v48, v32
    v_exp_f32 v49, v33
    v_exp_f32 v50, v34
    v_exp_f32 v51, v35
    v_mfma_f32_32x32x16_bf16 v[16:31], v[116:119], v[136:139], v[16:31]
    v_exp_f32 v52, v36
    v_exp_f32 v53, v37
    v_exp_f32 v54, v38
    v_exp_f32 v55, v39
    v_mfma_f32_32x32x16_bf16 v[16:31], v[120:123], v[140:143], v[16:31]
    v_exp_f32 v56, v40
    v_exp_f32 v57, v41
    v_exp_f32 v58, v42
    v_exp_f32 v59, v43
    v_exp_f32 v60, v44
    s_mov_b32 m0, s70
    ds_read_b128 v[124:127], v236 offset:13824
    ds_read2st64_b64 v[128:131], v237 offset0:24 offset1:25
    ds_read_b128 v[116:119], v239 offset:6144
    ds_read_b128 v[120:123], v240 offset:6144
    v_exp_f32 v61, v45
    v_exp_f32 v62, v46
    v_exp_f32 v63, v47
    v_pk_fma_f32 v[48:49], v[48:49], v[228:229], v[228:229] clamp
    v_pk_fma_f32 v[50:51], v[50:51], v[228:229], v[228:229] clamp
    v_pk_fma_f32 v[52:53], v[52:53], v[228:229], v[228:229] clamp
    v_pk_fma_f32 v[54:55], v[54:55], v[228:229], v[228:229] clamp
    v_pk_fma_f32 v[56:57], v[56:57], v[228:229], v[228:229] clamp
    v_pk_fma_f32 v[58:59], v[58:59], v[228:229], v[228:229] clamp
    v_pk_fma_f32 v[60:61], v[60:61], v[228:229], v[228:229] clamp
    buffer_load_dwordx4 v247, s[48:51], 0 offen offset:0  lds
    buffer_load_dwordx4 v247, s[48:51], 0 offen offset:1024  lds
    v_pk_fma_f32 v[62:63], v[62:63], v[228:229], v[228:229] clamp
    v_pk_mul_f32 v[32:33], v[32:33], v[52:53]
    v_pk_mul_f32 v[34:35], v[34:35], v[54:55]
    v_pk_fma_f32 v[32:33], v[36:37], v[48:49], v[32:33]
    v_pk_fma_f32 v[34:35], v[38:39], v[50:51], v[34:35]
    v_pk_mul_f32 v[48:49], v[48:49], v[52:53]
    v_pk_mul_f32 v[50:51], v[50:51], v[54:55]
    v_pk_mul_f32 v[40:41], v[40:41], v[60:61]
    v_pk_mul_f32 v[42:43], v[42:43], v[62:63]
    v_pk_fma_f32 v[40:41], v[44:45], v[56:57], v[40:41]
    s_cmp_le_i32 s63, 25
    v_pk_fma_f32 v[42:43], v[46:47], v[58:59], v[42:43]
    v_pk_mul_f32 v[56:57], v[56:57], v[60:61]
    v_pk_mul_f32 v[58:59], v[58:59], v[62:63]
    s_cbranch_scc1 M_evs25
M_evrs25:
    v_rcp_f32 v48, v48
    v_rcp_f32 v49, v49
    v_rcp_f32 v50, v50
    v_rcp_f32 v51, v51
    v_rcp_f32 v56, v56
    v_rcp_f32 v57, v57
    v_rcp_f32 v58, v58
    v_rcp_f32 v59, v59
    v_pk_mul_f32 v[32:33], v[32:33], v[48:49]
    v_pk_mul_f32 v[34:35], v[34:35], v[50:51]
    v_pk_fma_f32 v[32:33], v[40:41], v[56:57], v[32:33]
    v_pk_fma_f32 v[34:35], v[42:43], v[58:59], v[34:35]
    v_cvt_pk_bf16_f32 v66, v32, v33
    v_cvt_pk_bf16_f32 v67, v34, v35
    s_branch M_fin
M_tails0:
    s_lshl_b32 s3, s62, 9
    v_add_u32 v8, s3, v237
    v_mfma_f32_32x32x16_bf16 v[68:83], v[64:67], v[128:131], v[68:83]
    v_rcp_f32 v48, v48
    v_rcp_f32 v49, v49
    v_rcp_f32 v50, v50
    v_rcp_f32 v51, v51
    v_rcp_f32 v56, v56
    v_rcp_f32 v57, v57
    v_rcp_f32 v58, v58
    v_rcp_f32 v59, v59
    ds_read_b64 v[128:129], v8
    v_pk_mul_f32 v[16:17], v[16:17], v[48:49]
    v_pk_mul_f32 v[18:19], v[18:19], v[50:51]
    v_pk_fma_f32 v[16:17], v[24:25], v[56:57], v[16:17]
    v_pk_fma_f32 v[18:19], v[26:27], v[58:59], v[18:19]
    v_cvt_pk_bf16_f32 v64, v16, v17
    v_cvt_pk_bf16_f32 v65, v18, v19
    v_mov_b32 v130, 0
    v_mov_b32 v131, 0
    s_branch M_fin
M_tails1:
    s_lshl_b32 s3, s62, 9
    v_add_u32 v8, s3, v237
    v_rcp_f32 v48, v48
    v_rcp_f32 v49, v49
    v_rcp_f32 v50, v50
    v_rcp_f32 v51, v51
    v_rcp_f32 v56, v56
    v_rcp_f32 v57, v57
    v_rcp_f32 v58, v58
    v_rcp_f32 v59, v59
    v_pk_mul_f32 v[32:33], v[32:33], v[48:49]
    v_pk_mul_f32 v[34:35], v[34:35], v[50:51]
    v_pk_fma_f32 v[32:33], v[40:41], v[56:57], v[32:33]
    v_pk_fma_f32 v[34:35], v[42:43], v[58:59], v[34:35]
    v_cvt_pk_bf16_f32 v66, v32, v33
    v_cvt_pk_bf16_f32 v67, v34, v35
    s_branch M_fin
M_evs0:
    s_movk_i32 s62, 0
    s_call_b64 s[94:95], M_rare
    s_cbranch_scc1 M_tails0
    s_branch M_evrs0
M_evs1:
    s_movk_i32 s62, 1
    s_call_b64 s[94:95], M_rare
    s_cbranch_scc1 M_tails1
    s_branch M_evrs1
M_evs2:
    s_movk_i32 s62, 2
    s_call_b64 s[94:95], M_rare
    s_cbranch_scc1 M_tails0
    s_branch M_evrs2
M_evs3:
    s_movk_i32 s62, 3
    s_call_b64 s[94:95], M_rare
    s_cbranch_scc1 M_tails1
    s_branch M_evrs3
M_evs4:
    s_movk_i32 s62, 4
    s_call_b64 s[94:95], M_rare
    s_cbranch_scc1 M_tails0
    s_branch M_evrs4
M_evs5:
    s_movk_i32 s62, 5
    s_call_b64 s[94:95], M_rare
    s_cbranch_scc1 M_tails1
    s_branch M_evrs5
M_evs6:
    s_movk_i32 s62, 6
    s_call_b64 s[94:95], M_rare
    s_cbranch_scc1 M_tails0
    s_branch M_evrs6
M_evs7:
    s_movk_i32 s62, 7
    s_call_b64 s[94:95], M_rare
    s_cbranch_scc1 M_tails1
    s_branch M_evrs7
M_evs8:
    s_movk_i32 s62, 8
    s_call_b64 s[94:95], M_rare
    s_cbranch_scc1 M_tails0
    s_branch M_evrs8
M_evs9:
    s_movk_i32 s62, 9
    s_call_b64 s[94:95], M_rare
    s_cbranch_scc1 M_tails1
    s_branch M_evrs9
M_evs10:
    s_movk_i32 s62, 10
    s_call_b64 s[94:95], M_rare
    s_cbranch_scc1 M_tails0
    s_branch M_evrs10
M_evs11:
    s_movk_i32 s62, 11
    s_call_b64 s[94:95], M_rare
    s_cbranch_scc1 M_tails1
    s_branch M_evrs11
M_evs12:
    s_movk_i32 s62, 12
    s_call_b64 s[94:95], M_rare
    s_cbranch_scc1 M_tails0
    s_branch M_evrs12
M_evs13:
    s_movk_i32 s62, 13
    s_call_b64 s[94:95], M_rare
    s_cbranch_scc1 M_tails1
    s_branch M_evrs13
M_evs14:
    s_movk_i32 s62, 14
    s_call_b64 s[94:95], M_rare
    s_cbranch_scc1 M_tails0
    s_branch M_evrs14
M_evs15:
    s_movk_i32 s62, 15
    s_call_b64 s[94:95], M_rare
    s_cbranch_scc1 M_tails1
    s_branch M_evrs15
M_evs16:
    s_movk_i32 s62, 16
    s_call_b64 s[94:95], M_rare
    s_cbranch_scc1 M_tails0
    s_branch M_evrs16
M_evs17:
    s_movk_i32 s62, 17
    s_call_b64 s[94:95], M_rare
    s_cbranch_scc1 M_tails1
    s_branch M_evrs17
M_evs18:
    s_movk_i32 s62, 18
    s_call_b64 s[94:95], M_rare
    s_cbranch_scc1 M_tails0
    s_branch M_evrs18
M_evs19:
    s_movk_i32 s62, 19
    s_call_b64 s[94:95], M_rare
    s_cbranch_scc1 M_tails1
    s_branch M_evrs19
M_evs20:
    s_movk_i32 s62, 20
    s_call_b64 s[94:95], M_rare
    s_cbranch_scc1 M_tails0
    s_branch M_evrs20
M_evs21:
    s_movk_i32 s62, 21
    s_call_b64 s[94:95], M_rare
    s_cbranch_scc1 M_tails1
    s_branch M_evrs21
M_evs22:
    s_movk_i32 s62, 22
    s_call_b64 s[94:95], M_rare
    s_cbranch_scc1 M_tails0
    s_branch M_evrs22
M_evs23:
    s_movk_i32 s62, 23
    s_call_b64 s[94:95], M_rare
    s_cbranch_scc1 M_tails1
    s_branch M_evrs23
M_evs24:
    s_movk_i32 s62, 24
    s_call_b64 s[94:95], M_rare
    s_cbranch_scc1 M_tails0
    s_branch M_evrs24
M_evs25:
    s_movk_i32 s62, 25
    s_call_b64 s[94:95], M_rare
    s_cbranch_scc1 M_tails1
    s_branch M_evrs25
.section .rodata,"a"
.p2align 6
.amdhsa_kernel gather_scatter__edge_featured_mpnn_mpnn__graph_kernel
  .amdhsa_next_free_vgpr 256
  .amdhsa_next_free_sgpr 102
  .amdhsa_accum_offset 256
  .amdhsa_group_segment_fixed_size 0
  .amdhsa_kernarg_size 88
  .amdhsa_user_sgpr_count 2
  .amdhsa_user_sgpr_kernarg_segment_ptr 1
  .amdhsa_system_sgpr_workgroup_id_x 1
.end_amdhsa_kernel
```
